```python
import torch

def _softmax(x, axis=-1):
    return torch.softmax(x, dim=axis)
def _gelu(x):
    return torch.nn.functional.gelu(x, approximate="tanh")
def _silu(x):
    return torch.nn.functional.silu(x)
def _sigmoid(x):
    return torch.sigmoid(x)
def _layernorm(x, axis=-1, eps=1e-5):
    m = x.mean(dim=axis, keepdim=True)
    v = x.var(dim=axis, keepdim=True, unbiased=False)
    return (x - m) / torch.sqrt(v + eps)
def _scatter_add(tgt, idx, src, axis=0):
    return tgt.clone().index_add_(axis, idx, src)
def _segment_sum(src, seg, n):
    out = torch.zeros((n,) + src.shape[1:], dtype=src.dtype)
    return out.index_add_(0, seg, src)
def _pad(x, pw):
    flat = tuple(v for pair in reversed(pw) for v in pair)
    return torch.nn.functional.pad(x, flat)

kernel_name = 'gated_mix__sliding_local_dilated__dense_activation_squared_relu__prompt'

def setup_inputs():

    _w = (lambda a: (lambda t: t.to(torch.bfloat16) if t.is_floating_point() else t)(torch.as_tensor(a)))
    def _A_setup():
        B, S, D = 1, 2048, 448
        return {
            "x": _w((lambda *s: torch.randn(*s, dtype=torch.bfloat16) * 0.05)(B, S, D)),
            "wqkv": _w((lambda *s: torch.randn(*s, dtype=torch.bfloat16) * 0.8)(D, 3 * D)),
            "wo": _w((lambda *s: torch.randn(*s, dtype=torch.bfloat16) * 0.05)(D, D)),
        }
    _A_in = _A_setup()

    def _B_setup():
        B, S, D, F = 1, 2048, 448, 1792
        return {
            "x": _w((lambda *s: torch.randn(*s, dtype=torch.bfloat16) * 0.05)(B, S, D)),
            "w1": _w((lambda *s: torch.randn(*s, dtype=torch.bfloat16) * 0.1)(D, F)),
            "b1": _w((lambda *s: torch.randn(*s, dtype=torch.bfloat16) * 0.1)(F)),
            "w2": _w((lambda *s: torch.randn(*s, dtype=torch.bfloat16) * 0.1)(F, D)),
            "b2": _w((lambda *s: torch.randn(*s, dtype=torch.bfloat16) * 0.1)(D)),
        }
    _B_in = _B_setup()

    return {
        "A_x": _A_in["x"],
        "A_wqkv": _A_in["wqkv"],
        "A_wo": _A_in["wo"],
        "B_x": _B_in["x"],
        "B_w1": _B_in["w1"],
        "B_b1": _B_in["b1"],
        "B_w2": _B_in["w2"],
        "B_b2": _B_in["b2"],
        "gate_w": _w((lambda *s: torch.randn(*s, dtype=torch.bfloat16) * 0.05)(448) * 16.0),
    }

def reference(A_x, A_wqkv, A_wo, B_x, B_w1, B_b1, B_w2, B_b2, gate_w):
    def _A_ref(x, wqkv, wo):
        B, S, D = x.shape
        H = 16; Dh = D // H
        W, dil = 8, 2
        qkv = (lambda x, *d: x.permute(*d))((x @ wqkv).reshape(B, S, 3, H, Dh), 2, 0, 3, 1, 4)
        q, k, v = qkv[0], qkv[1], qkv[2]
        scale = Dh ** -0.5
        pos = torch.arange(S)
        off = torch.arange(W) * dil
        idx = pos[:, None] - off[None, :]
        mask = idx >= 0
        idx_c = torch.where(mask, idx, 0).reshape(-1)
        kg = k[:, :, idx_c, :].reshape(B, H, S, W, Dh)
        vg = v[:, :, idx_c, :].reshape(B, H, S, W, Dh)
        logits = torch.einsum("bhsd,bhswd->bhsw", q, kg) * scale
        logits = torch.where(mask[None, None, :, :], logits, -1e9)
        attn = _softmax(logits, axis=-1)
        o = torch.einsum("bhsw,bhswd->bhsd", attn, vg)
        return (lambda x, *d: x.permute(*d))(o, 0, 2, 1, 3).reshape(B, S, D) @ wo

    def _B_ref(x, w1, b1, w2, b2):
        h = torch.einsum("bsd,df->bsf", x, w1) + b1
        zero = torch.zeros_like(h)
        r = torch.where(h > zero, h, zero)
        h = r * r
        out = torch.einsum("bsf,fd->bsd", h, w2) + b2
        return out

    x = A_x
    g = _sigmoid((x * gate_w).sum(-1, keepdims=True))
    a = _A_ref(x, A_wqkv, A_wo)
    b = _B_ref(x, B_w1, B_b1, B_w2, B_b2)
    return g * a + (1 - g) * b
```

```asm
; @launch grid=(256,1,1) block=(512,1,1) lds=163840
.amdgcn_target "amdgcn-amd-amdhsa--gfx950"
.text
.globl gated_mix__sliding_local_dilated__dense_activation_squared_relu__prompt_kernel
.p2align 8
.type gated_mix__sliding_local_dilated__dense_activation_squared_relu__prompt_kernel,@function
gated_mix__sliding_local_dilated__dense_activation_squared_relu__prompt_kernel:
    s_cmp_ge_u32 s2, 256
    s_cbranch_scc1 gated_mix__sliding_local_dilated__dense_activation_squared_relu__prompt_kernel_end
    s_load_dwordx16 s[48:63], s[0:1], 0
    s_load_dwordx8 s[64:71], s[0:1], 64
    v_lshrrev_b32 v8, 6, v0
    v_and_b32 v1, 63, v0
    v_readfirstlane_b32 s3, v8
    v_lshlrev_b32 v2, 4, v1
    v_and_b32 v8, 15, v1
    v_lshrrev_b32 v9, 4, v1
    v_lshrrev_b32 v10, 3, v1
    v_and_b32 v11, 7, v1
    s_and_b32 s86, s3, 3
    s_lshr_b32 s84, s2, 3
    s_and_b32 s4, s2, 1
    s_lshl_b32 s4, s4, 3
    s_and_b32 s85, s84, 7
    s_add_u32 s4, s4, s85
    s_bfe_u32 s5, s2, 0x20001
    s_mul_i32 s87, s5, 896
    s_lshl_b32 s5, s5, 2
    s_lshr_b32 s85, s84, 3
    s_add_u32 s5, s5, s85
    s_lshl_b32 s84, s85, 8
    s_cmp_eq_u32 s85, 3
    s_cselect_b32 s84, 640, s84
    s_add_u32 s87, s87, s84
    s_cmp_ge_u32 s3, 4
    s_cbranch_scc1 gated_mix__sliding_local_dilated__dense_activation_squared_relu__prompt_kernel_C
    s_cmp_ge_u32 s3, 2
    s_cbranch_scc1 gated_mix__sliding_local_dilated__dense_activation_squared_relu__prompt_kernel_S
    v_mul_u32_u24 v15, 896, v10
    v_xor_b32 v14, v11, v10
    v_lshl_add_u32 v24, v14, 4, v15
    v_mul_u32_u24 v15, 3584, v9
    v_lshlrev_b32 v14, 1, v9
    v_xor_b32 v14, v14, v8
    v_lshl_add_u32 v25, v14, 4, v15
    v_xor_b32 v26, 0x80, v25
    s_lshl_b32 s84, s5, 1
    s_add_u32 s84, s84, s4
    s_mul_i32 s85, s84, 37
    s_lshr_b32 s85, s85, 8
    s_mul_i32 s85, s85, 7
    s_sub_u32 s94, s84, s85
    s_mul_i32 s88, s86, 114688
    s_add_u32 s88, s88, s87
    s_lshl_b32 s84, s4, 7
    s_lshl_b32 s85, s86, 6
    s_add_u32 s85, s84, s85
    s_mul_i32 s89, s85, 896
    s_lshl_b32 s90, s86, 13
    s_waitcnt lgkmcnt(0)
    s_mov_b32 s16, s56
    s_and_b32 s17, s57, 0xffff
    s_mov_b32 s18, 1605632
    s_mov_b32 s19, 0x20000
    s_mov_b32 s8, s48
    s_and_b32 s9, s49, 0xffff
    s_mov_b32 s10, 1835008
    s_mov_b32 s11, 0x20000
    s_mov_b32 s36, s58
    s_and_b32 s37, s59, 0xffff
    s_mov_b32 s38, 3584
    s_mov_b32 s39, 0x20000
    s_cmp_lg_u32 s86, 0
    s_cbranch_scc1 Lw01
    s_mov_b32 m0, 145408
    s_mov_b64 exec, 0xffff
    buffer_load_dwordx4 v2, s[36:39], s87 offen lds
    s_mov_b64 exec, -1
Lw01:
    s_add_u32 s93, s94, 0
    s_sub_u32 s85, s93, 7
    s_cmp_ge_u32 s93, 7
    s_cselect_b32 s93, s85, s93
    s_mul_i32 s93, s93, 229376
    s_add_u32 s93, s93, s88
    s_add_u32 m0, s90, 0
    s_add_u32 s84, s93, 0
    buffer_load_dwordx4 v25, s[16:19], s84 offen  lds
    s_add_u32 m0, s90, 1024
    s_add_u32 s84, s93, 28672
    buffer_load_dwordx4 v26, s[16:19], s84 offen  lds
    s_add_u32 m0, s90, 2048
    s_add_u32 s84, s93, 57344
    buffer_load_dwordx4 v25, s[16:19], s84 offen  lds
    s_add_u32 m0, s90, 3072
    s_add_u32 s84, s93, 86016
    buffer_load_dwordx4 v26, s[16:19], s84 offen  lds
    s_add_u32 m0, s90, 4096
    s_add_u32 s84, s93, 14336
    buffer_load_dwordx4 v25, s[16:19], s84 offen  lds
    s_add_u32 m0, s90, 5120
    s_add_u32 s84, s93, 43008
    buffer_load_dwordx4 v26, s[16:19], s84 offen  lds
    s_add_u32 m0, s90, 6144
    s_add_u32 s84, s93, 71680
    buffer_load_dwordx4 v25, s[16:19], s84 offen  lds
    s_add_u32 m0, s90, 7168
    s_add_u32 s84, s93, 100352
    buffer_load_dwordx4 v26, s[16:19], s84 offen  lds
    s_add_u32 s93, s94, 0
    s_sub_u32 s85, s93, 7
    s_cmp_ge_u32 s93, 7
    s_cselect_b32 s93, s85, s93
    s_mul_i32 s93, s93, 128
    s_add_u32 s93, s93, s89
    s_add_u32 m0, s90, 65536
    s_add_u32 s84, s93, 0
    buffer_load_dwordx4 v24, s[8:11], s84 offen  lds
    s_add_u32 m0, s90, 66560
    s_add_u32 s84, s93, 7168
    buffer_load_dwordx4 v24, s[8:11], s84 offen  lds
    s_add_u32 m0, s90, 67584
    s_add_u32 s84, s93, 14336
    buffer_load_dwordx4 v24, s[8:11], s84 offen  lds
    s_add_u32 m0, s90, 68608
    s_add_u32 s84, s93, 21504
    buffer_load_dwordx4 v24, s[8:11], s84 offen  lds
    s_add_u32 m0, s90, 69632
    s_add_u32 s84, s93, 28672
    buffer_load_dwordx4 v24, s[8:11], s84 offen  lds
    s_add_u32 m0, s90, 70656
    s_add_u32 s84, s93, 35840
    buffer_load_dwordx4 v24, s[8:11], s84 offen  lds
    s_add_u32 m0, s90, 71680
    s_add_u32 s84, s93, 43008
    buffer_load_dwordx4 v24, s[8:11], s84 offen  lds
    s_add_u32 m0, s90, 72704
    s_add_u32 s84, s93, 50176
    buffer_load_dwordx4 v24, s[8:11], s84 offen  lds
    v_lshlrev_b32 v5, 3, v1
    v_mov_b32 v4, 0
    v_mov_b32 v16, 146944
    v_and_b32 v12, 3, v1
    v_lshrrev_b32 v13, 2, v1
    s_and_b32 s6, s2, 7
    s_lshl_b32 s6, s6, 2
    s_bfe_u32 s85, s2, 0x20003
    s_add_u32 s6, s6, s85
    s_lshr_b32 s7, s2, 5
    s_mov_b32 s80, -1
    s_mov_b32 s81, 0
    s_mov_b32 s92, 0
    s_lshl_b32 s84, s86, 2
    s_add_u32 s84, s84, 146944
    v_lshlrev_b32 v17, 2, v1
    v_add_u32 v17, 146560, v17
    v_writelane_b32 v17, s84, 0
    s_barrier
    s_mov_b32 s12, s50
    s_and_b32 s13, s51, 0xffff
    s_mov_b32 s14, 1204224
    s_mov_b32 s15, 0x20000
    s_mov_b32 s24, s52
    s_and_b32 s25, s53, 0xffff
    s_mov_b32 s26, 401408
    s_mov_b32 s27, 0x20000
    s_mov_b32 s28, s60
    s_and_b32 s29, s61, 0xffff
    s_mov_b32 s30, 1605632
    s_mov_b32 s31, 0x20000
    s_mov_b32 s40, s64
    s_and_b32 s41, s65, 0xffff
    s_mov_b32 s42, 896
    s_mov_b32 s43, 0x20000
    s_mov_b32 s44, s62
    s_and_b32 s45, s63, 0xffff
    s_mov_b32 s46, 896
    s_mov_b32 s47, 0x20000
    s_mov_b32 s32, s66
    s_and_b32 s33, s67, 0xffff
    s_mov_b32 s34, 1835008
    s_mov_b32 s35, 0x20000
    s_mov_b32 s20, s70
    s_and_b32 s21, s71, 0xffff
    s_mov_b32 s22, 11104256
    s_mov_b32 s23, 0x20000
    s_mov_b64 s[0:1], s[70:71]
    s_mov_b32 s49, s88
    s_mov_b32 s48, s89
    s_mov_b32 s53, s90
    s_add_u32 s93, s94, 1
    s_sub_u32 s85, s93, 7
    s_cmp_ge_u32 s93, 7
    s_cselect_b32 s93, s85, s93
    s_mul_i32 s93, s93, 229376
    s_add_u32 s93, s93, s49
    s_add_u32 m0, s53, 16384
    s_add_u32 s84, s93, 0
    buffer_load_dwordx4 v25, s[16:19], s84 offen  lds
    s_add_u32 m0, s53, 17408
    s_add_u32 s84, s93, 28672
    buffer_load_dwordx4 v26, s[16:19], s84 offen  lds
    s_add_u32 m0, s53, 18432
    s_add_u32 s84, s93, 57344
    buffer_load_dwordx4 v25, s[16:19], s84 offen  lds
    s_add_u32 m0, s53, 19456
    s_add_u32 s84, s93, 86016
    buffer_load_dwordx4 v26, s[16:19], s84 offen  lds
    s_add_u32 m0, s53, 20480
    s_add_u32 s84, s93, 14336
    buffer_load_dwordx4 v25, s[16:19], s84 offen  lds
    s_add_u32 m0, s53, 21504
    s_add_u32 s84, s93, 43008
    buffer_load_dwordx4 v26, s[16:19], s84 offen  lds
    s_add_u32 m0, s53, 22528
    s_add_u32 s84, s93, 71680
    buffer_load_dwordx4 v25, s[16:19], s84 offen  lds
    s_add_u32 m0, s53, 23552
    s_add_u32 s84, s93, 100352
    buffer_load_dwordx4 v26, s[16:19], s84 offen  lds
    s_add_u32 s93, s94, 1
    s_sub_u32 s85, s93, 7
    s_cmp_ge_u32 s93, 7
    s_cselect_b32 s93, s85, s93
    s_mul_i32 s93, s93, 128
    s_add_u32 s93, s93, s48
    s_add_u32 m0, s53, 81920
    s_add_u32 s84, s93, 0
    buffer_load_dwordx4 v24, s[8:11], s84 offen  lds
    s_add_u32 m0, s53, 82944
    s_add_u32 s84, s93, 7168
    buffer_load_dwordx4 v24, s[8:11], s84 offen  lds
    s_add_u32 m0, s53, 83968
    s_add_u32 s84, s93, 14336
    buffer_load_dwordx4 v24, s[8:11], s84 offen  lds
    s_add_u32 m0, s53, 84992
    s_add_u32 s84, s93, 21504
    buffer_load_dwordx4 v24, s[8:11], s84 offen  lds
    s_add_u32 m0, s53, 86016
    s_add_u32 s84, s93, 28672
    buffer_load_dwordx4 v24, s[8:11], s84 offen  lds
    s_add_u32 m0, s53, 87040
    s_add_u32 s84, s93, 35840
    buffer_load_dwordx4 v24, s[8:11], s84 offen  lds
    s_add_u32 m0, s53, 88064
    s_add_u32 s84, s93, 43008
    buffer_load_dwordx4 v24, s[8:11], s84 offen  lds
    s_add_u32 m0, s53, 89088
    s_add_u32 s84, s93, 50176
    buffer_load_dwordx4 v24, s[8:11], s84 offen  lds
    v_mul_u32_u24 v15, 896, v10
    v_and_b32 v14, 1, v9
    v_xor_b32 v14, v14, v11
    v_lshl_add_u32 v28, v14, 4, v15
    s_lshl_b32 s52, s86, 12
    s_lshl_b32 s84, s6, 8
    s_add_u32 s55, s84, 9445376
    s_mul_i32 s56, s6, 294912
    s_lshl_b32 s61, s7, 7
    s_mul_i32 s57, s86, 100352
    s_add_u32 s57, s57, s61
    s_mul_i32 s58, s86, 401408
    s_add_u32 s58, s58, s61
    s_mul_i32 s84, s86, 14336
    s_add_u32 s62, s56, s84
    s_add_u32 s63, s56, s52
    s_add_u32 s63, s63, 57344
    s_and_b32 s84, s6, 3
    s_mul_i32 s84, s84, 7
    s_add_u32 s84, s84, 1
    s_lshr_b32 s84, s84, 1
    s_lshl_b32 s85, s7, 1
    s_add_u32 s84, s84, s85
    s_sub_u32 s85, s84, 14
    s_cmp_ge_u32 s84, 14
    s_cselect_b32 s95, s85, s84
    s_add_u32 s84, s6, s7
    s_and_b32 s96, s84, 3
    s_mul_i32 s50, s86, 2048
    s_mul_i32 s85, s5, 86016
    s_add_u32 s50, s50, s85
    s_lshl_b32 s84, s4, 7
    s_sub_i32 s84, s84, 16
    s_max_i32 s84, s84, 0
    s_lshl_b32 s85, s86, 3
    s_add_u32 s84, s84, s85
    s_mul_i32 s51, s84, 896
    s_lshl_b32 s54, s86, 11
    s_lshl_b32 s60, s86, 10
    v_and_b32 v14, 3, v13
    v_lshl_add_u32 v14, v9, 3, v14
    v_mul_u32_u24 v27, 64, v14
    v_and_b32 v14, 1, v9
    v_lshlrev_b32 v15, 1, v14
    v_xor_b32 v15, v15, v12
    v_lshl_add_u32 v27, v15, 4, v27
    s_waitcnt vmcnt(16)
    v_mov_b32 v18, 2
    ds_max_u32 v17, v18 offset:0
    s_add_u32 s93, s94, 2
    s_sub_u32 s85, s93, 7
    s_cmp_ge_u32 s93, 7
    s_cselect_b32 s93, s85, s93
    s_mul_i32 s93, s93, 229376
    s_add_u32 s93, s93, s49
    s_add_u32 m0, s53, 32768
    s_add_u32 s84, s93, 0
    buffer_load_dwordx4 v25, s[16:19], s84 offen  lds
    s_add_u32 m0, s53, 33792
    s_add_u32 s84, s93, 28672
    buffer_load_dwordx4 v26, s[16:19], s84 offen  lds
    s_add_u32 m0, s53, 34816
    s_add_u32 s84, s93, 57344
    buffer_load_dwordx4 v25, s[16:19], s84 offen  lds
    s_add_u32 m0, s53, 35840
    s_add_u32 s84, s93, 86016
    buffer_load_dwordx4 v26, s[16:19], s84 offen  lds
    s_add_u32 m0, s53, 36864
    s_add_u32 s84, s93, 14336
    buffer_load_dwordx4 v25, s[16:19], s84 offen  lds
    s_add_u32 m0, s53, 37888
    s_add_u32 s84, s93, 43008
    buffer_load_dwordx4 v26, s[16:19], s84 offen  lds
    s_add_u32 m0, s53, 38912
    s_add_u32 s84, s93, 71680
    buffer_load_dwordx4 v25, s[16:19], s84 offen  lds
    s_add_u32 m0, s53, 39936
    s_add_u32 s84, s93, 100352
    buffer_load_dwordx4 v26, s[16:19], s84 offen  lds
    s_add_u32 s93, s94, 2
    s_sub_u32 s85, s93, 7
    s_cmp_ge_u32 s93, 7
    s_cselect_b32 s93, s85, s93
    s_mul_i32 s93, s93, 128
    s_add_u32 s93, s93, s48
    s_add_u32 m0, s53, 98304
    s_add_u32 s84, s93, 0
    buffer_load_dwordx4 v24, s[8:11], s84 offen  lds
    s_add_u32 m0, s53, 99328
    s_add_u32 s84, s93, 7168
    buffer_load_dwordx4 v24, s[8:11], s84 offen  lds
    s_add_u32 m0, s53, 100352
    s_add_u32 s84, s93, 14336
    buffer_load_dwordx4 v24, s[8:11], s84 offen  lds
    s_add_u32 m0, s53, 101376
    s_add_u32 s84, s93, 21504
    buffer_load_dwordx4 v24, s[8:11], s84 offen  lds
    s_add_u32 m0, s53, 102400
    s_add_u32 s84, s93, 28672
    buffer_load_dwordx4 v24, s[8:11], s84 offen  lds
    s_add_u32 m0, s53, 103424
    s_add_u32 s84, s93, 35840
    buffer_load_dwordx4 v24, s[8:11], s84 offen  lds
    s_add_u32 m0, s53, 104448
    s_add_u32 s84, s93, 43008
    buffer_load_dwordx4 v24, s[8:11], s84 offen  lds
    s_add_u32 m0, s53, 105472
    s_add_u32 s84, s93, 50176
    buffer_load_dwordx4 v24, s[8:11], s84 offen  lds
    s_add_u32 s93, s94, 3
    s_sub_u32 s85, s93, 7
    s_cmp_ge_u32 s93, 7
    s_cselect_b32 s93, s85, s93
    s_mul_i32 s93, s93, 229376
    s_add_u32 s93, s93, s49
    s_add_u32 m0, s53, 49152
    s_add_u32 s84, s93, 0
    buffer_load_dwordx4 v25, s[16:19], s84 offen  lds
    s_add_u32 m0, s53, 50176
    s_add_u32 s84, s93, 28672
    buffer_load_dwordx4 v26, s[16:19], s84 offen  lds
    s_add_u32 m0, s53, 51200
    s_add_u32 s84, s93, 57344
    buffer_load_dwordx4 v25, s[16:19], s84 offen  lds
    s_add_u32 m0, s53, 52224
    s_add_u32 s84, s93, 86016
    buffer_load_dwordx4 v26, s[16:19], s84 offen  lds
    s_add_u32 m0, s53, 53248
    s_add_u32 s84, s93, 14336
    buffer_load_dwordx4 v25, s[16:19], s84 offen  lds
    s_add_u32 m0, s53, 54272
    s_add_u32 s84, s93, 43008
    buffer_load_dwordx4 v26, s[16:19], s84 offen  lds
    s_add_u32 m0, s53, 55296
    s_add_u32 s84, s93, 71680
    buffer_load_dwordx4 v25, s[16:19], s84 offen  lds
    s_add_u32 m0, s53, 56320
    s_add_u32 s84, s93, 100352
    buffer_load_dwordx4 v26, s[16:19], s84 offen  lds
    s_waitcnt vmcnt(24)
    v_mov_b32 v18, 4
    ds_max_u32 v17, v18 offset:0
    ds_read_b128 v[20:23], v16 offset:16
    s_add_u32 s93, s94, 3
    s_sub_u32 s85, s93, 7
    s_cmp_ge_u32 s93, 7
    s_cselect_b32 s93, s85, s93
    s_mul_i32 s93, s93, 128
    s_add_u32 s93, s93, s48
    s_add_u32 m0, s53, 114688
    s_add_u32 s84, s93, 0
    buffer_load_dwordx4 v24, s[8:11], s84 offen  lds
    s_add_u32 m0, s53, 115712
    s_add_u32 s84, s93, 7168
    buffer_load_dwordx4 v24, s[8:11], s84 offen  lds
    s_add_u32 m0, s53, 116736
    s_add_u32 s84, s93, 14336
    buffer_load_dwordx4 v24, s[8:11], s84 offen  lds
    s_add_u32 m0, s53, 117760
    s_add_u32 s84, s93, 21504
    buffer_load_dwordx4 v24, s[8:11], s84 offen  lds
    s_add_u32 m0, s53, 118784
    s_add_u32 s84, s93, 28672
    buffer_load_dwordx4 v24, s[8:11], s84 offen  lds
    s_add_u32 m0, s53, 119808
    s_add_u32 s84, s93, 35840
    buffer_load_dwordx4 v24, s[8:11], s84 offen  lds
    s_add_u32 m0, s53, 120832
    s_add_u32 s84, s93, 43008
    buffer_load_dwordx4 v24, s[8:11], s84 offen  lds
    s_add_u32 m0, s53, 121856
    s_add_u32 s84, s93, 50176
    buffer_load_dwordx4 v24, s[8:11], s84 offen  lds
    s_waitcnt lgkmcnt(0)
    v_min3_u32 v20, v20, v21, v22
    v_min_u32 v20, v20, v23
    s_nop 0
    v_readfirstlane_b32 s85, v20
    s_cmp_ge_u32 s85, 1
    s_cbranch_scc1 Llk3
    s_waitcnt vmcnt(16)
    v_mov_b32 v18, 6
    ds_max_u32 v17, v18 offset:0
    ds_read_b128 v[20:23], v16 offset:16
    s_waitcnt lgkmcnt(0)
    v_min3_u32 v20, v20, v21, v22
    v_min_u32 v20, v20, v23
    s_nop 0
    v_readfirstlane_b32 s85, v20
    s_cmp_ge_u32 s85, 1
    s_cbranch_scc1 Llk3
    s_waitcnt vmcnt(0)
    v_mov_b32 v18, 8
    ds_max_u32 v17, v18 offset:0
    ds_read_b128 v[20:23], v16 offset:16
    s_waitcnt lgkmcnt(0)
Llw2:
    v_min3_u32 v20, v20, v21, v22
    v_min_u32 v20, v20, v23
    s_nop 0
    v_readfirstlane_b32 s85, v20
    s_cmp_ge_u32 s85, 1
    s_cbranch_scc1 Llk3
    s_sleep 1
    ds_read_b128 v[20:23], v16 offset:16
    s_waitcnt lgkmcnt(0)
    s_add_u32 s92, s92, 1
    s_cmp_lt_u32 s92, 0x200000
    s_cbranch_scc1 Llw2
Llk3:
    s_add_u32 s93, s94, 4
    s_sub_u32 s85, s93, 7
    s_cmp_ge_u32 s93, 7
    s_cselect_b32 s93, s85, s93
    s_mul_i32 s93, s93, 229376
    s_add_u32 s93, s93, s49
    s_add_u32 m0, s53, 0
    s_add_u32 s84, s93, 0
    buffer_load_dwordx4 v25, s[16:19], s84 offen  lds
    s_add_u32 m0, s53, 1024
    s_add_u32 s84, s93, 28672
    buffer_load_dwordx4 v26, s[16:19], s84 offen  lds
    s_add_u32 m0, s53, 2048
    s_add_u32 s84, s93, 57344
    buffer_load_dwordx4 v25, s[16:19], s84 offen  lds
    s_add_u32 m0, s53, 3072
    s_add_u32 s84, s93, 86016
    buffer_load_dwordx4 v26, s[16:19], s84 offen  lds
    s_add_u32 m0, s53, 4096
    s_add_u32 s84, s93, 14336
    buffer_load_dwordx4 v25, s[16:19], s84 offen  lds
    s_add_u32 m0, s53, 5120
    s_add_u32 s84, s93, 43008
    buffer_load_dwordx4 v26, s[16:19], s84 offen  lds
    s_add_u32 m0, s53, 6144
    s_add_u32 s84, s93, 71680
    buffer_load_dwordx4 v25, s[16:19], s84 offen  lds
    s_add_u32 m0, s53, 7168
    s_add_u32 s84, s93, 100352
    buffer_load_dwordx4 v26, s[16:19], s84 offen  lds
    s_waitcnt vmcnt(24)
    v_mov_b32 v18, 6
    ds_max_u32 v17, v18 offset:0
    ds_read_b128 v[20:23], v16 offset:16
    s_add_u32 s93, s94, 4
    s_sub_u32 s85, s93, 7
    s_cmp_ge_u32 s93, 7
    s_cselect_b32 s93, s85, s93
    s_mul_i32 s93, s93, 128
    s_add_u32 s93, s93, s48
    s_add_u32 m0, s53, 65536
    s_add_u32 s84, s93, 0
    buffer_load_dwordx4 v24, s[8:11], s84 offen  lds
    s_add_u32 m0, s53, 66560
    s_add_u32 s84, s93, 7168
    buffer_load_dwordx4 v24, s[8:11], s84 offen  lds
    s_add_u32 m0, s53, 67584
    s_add_u32 s84, s93, 14336
    buffer_load_dwordx4 v24, s[8:11], s84 offen  lds
    s_add_u32 m0, s53, 68608
    s_add_u32 s84, s93, 21504
    buffer_load_dwordx4 v24, s[8:11], s84 offen  lds
    s_add_u32 m0, s53, 69632
    s_add_u32 s84, s93, 28672
    buffer_load_dwordx4 v24, s[8:11], s84 offen  lds
    s_add_u32 m0, s53, 70656
    s_add_u32 s84, s93, 35840
    buffer_load_dwordx4 v24, s[8:11], s84 offen  lds
    s_add_u32 m0, s53, 71680
    s_add_u32 s84, s93, 43008
    buffer_load_dwordx4 v24, s[8:11], s84 offen  lds
    s_add_u32 m0, s53, 72704
    s_add_u32 s84, s93, 50176
    buffer_load_dwordx4 v24, s[8:11], s84 offen  lds
    s_waitcnt lgkmcnt(0)
    v_min3_u32 v20, v20, v21, v22
    v_min_u32 v20, v20, v23
    s_nop 0
    v_readfirstlane_b32 s85, v20
    s_cmp_ge_u32 s85, 2
    s_cbranch_scc1 Llk5
    s_waitcnt vmcnt(16)
    v_mov_b32 v18, 8
    ds_max_u32 v17, v18 offset:0
    ds_read_b128 v[20:23], v16 offset:16
    s_waitcnt lgkmcnt(0)
    v_min3_u32 v20, v20, v21, v22
    v_min_u32 v20, v20, v23
    s_nop 0
    v_readfirstlane_b32 s85, v20
    s_cmp_ge_u32 s85, 2
    s_cbranch_scc1 Llk5
    s_waitcnt vmcnt(0)
    v_mov_b32 v18, 10
    ds_max_u32 v17, v18 offset:0
    ds_read_b128 v[20:23], v16 offset:16
    s_waitcnt lgkmcnt(0)
Llw4:
    v_min3_u32 v20, v20, v21, v22
    v_min_u32 v20, v20, v23
    s_nop 0
    v_readfirstlane_b32 s85, v20
    s_cmp_ge_u32 s85, 2
    s_cbranch_scc1 Llk5
    s_sleep 1
    ds_read_b128 v[20:23], v16 offset:16
    s_waitcnt lgkmcnt(0)
    s_add_u32 s92, s92, 1
    s_cmp_lt_u32 s92, 0x200000
    s_cbranch_scc1 Llw4
Llk5:
    s_add_u32 s93, s94, 5
    s_sub_u32 s85, s93, 7
    s_cmp_ge_u32 s93, 7
    s_cselect_b32 s93, s85, s93
    s_mul_i32 s93, s93, 229376
    s_add_u32 s93, s93, s49
    s_add_u32 m0, s53, 16384
    s_add_u32 s84, s93, 0
    buffer_load_dwordx4 v25, s[16:19], s84 offen  lds
    s_add_u32 m0, s53, 17408
    s_add_u32 s84, s93, 28672
    buffer_load_dwordx4 v26, s[16:19], s84 offen  lds
    s_add_u32 m0, s53, 18432
    s_add_u32 s84, s93, 57344
    buffer_load_dwordx4 v25, s[16:19], s84 offen  lds
    s_add_u32 m0, s53, 19456
    s_add_u32 s84, s93, 86016
    buffer_load_dwordx4 v26, s[16:19], s84 offen  lds
    s_add_u32 m0, s53, 20480
    s_add_u32 s84, s93, 14336
    buffer_load_dwordx4 v25, s[16:19], s84 offen  lds
    s_add_u32 m0, s53, 21504
    s_add_u32 s84, s93, 43008
    buffer_load_dwordx4 v26, s[16:19], s84 offen  lds
    s_add_u32 m0, s53, 22528
    s_add_u32 s84, s93, 71680
    buffer_load_dwordx4 v25, s[16:19], s84 offen  lds
    s_add_u32 m0, s53, 23552
    s_add_u32 s84, s93, 100352
    buffer_load_dwordx4 v26, s[16:19], s84 offen  lds
    s_waitcnt vmcnt(24)
    v_mov_b32 v18, 8
    ds_max_u32 v17, v18 offset:0
    ds_read_b128 v[20:23], v16 offset:16
    s_add_u32 s93, s94, 5
    s_sub_u32 s85, s93, 7
    s_cmp_ge_u32 s93, 7
    s_cselect_b32 s93, s85, s93
    s_mul_i32 s93, s93, 128
    s_add_u32 s93, s93, s48
    s_add_u32 m0, s53, 81920
    s_add_u32 s84, s93, 0
    buffer_load_dwordx4 v24, s[8:11], s84 offen  lds
    s_add_u32 m0, s53, 82944
    s_add_u32 s84, s93, 7168
    buffer_load_dwordx4 v24, s[8:11], s84 offen  lds
    s_add_u32 m0, s53, 83968
    s_add_u32 s84, s93, 14336
    buffer_load_dwordx4 v24, s[8:11], s84 offen  lds
    s_add_u32 m0, s53, 84992
    s_add_u32 s84, s93, 21504
    buffer_load_dwordx4 v24, s[8:11], s84 offen  lds
    s_add_u32 m0, s53, 86016
    s_add_u32 s84, s93, 28672
    buffer_load_dwordx4 v24, s[8:11], s84 offen  lds
    s_add_u32 m0, s53, 87040
    s_add_u32 s84, s93, 35840
    buffer_load_dwordx4 v24, s[8:11], s84 offen  lds
    s_add_u32 m0, s53, 88064
    s_add_u32 s84, s93, 43008
    buffer_load_dwordx4 v24, s[8:11], s84 offen  lds
    s_add_u32 m0, s53, 89088
    s_add_u32 s84, s93, 50176
    buffer_load_dwordx4 v24, s[8:11], s84 offen  lds
    s_waitcnt lgkmcnt(0)
    v_min3_u32 v20, v20, v21, v22
    v_min_u32 v20, v20, v23
    s_nop 0
    v_readfirstlane_b32 s85, v20
    s_cmp_ge_u32 s85, 3
    s_cbranch_scc1 Llk7
    s_waitcnt vmcnt(16)
    v_mov_b32 v18, 10
    ds_max_u32 v17, v18 offset:0
    ds_read_b128 v[20:23], v16 offset:16
    s_waitcnt lgkmcnt(0)
    v_min3_u32 v20, v20, v21, v22
    v_min_u32 v20, v20, v23
    s_nop 0
    v_readfirstlane_b32 s85, v20
    s_cmp_ge_u32 s85, 3
    s_cbranch_scc1 Llk7
    s_waitcnt vmcnt(0)
    v_mov_b32 v18, 12
    ds_max_u32 v17, v18 offset:0
    ds_read_b128 v[20:23], v16 offset:16
    s_waitcnt lgkmcnt(0)
Llw6:
    v_min3_u32 v20, v20, v21, v22
    v_min_u32 v20, v20, v23
    s_nop 0
    v_readfirstlane_b32 s85, v20
    s_cmp_ge_u32 s85, 3
    s_cbranch_scc1 Llk7
    s_sleep 1
    ds_read_b128 v[20:23], v16 offset:16
    s_waitcnt lgkmcnt(0)
    s_add_u32 s92, s92, 1
    s_cmp_lt_u32 s92, 0x200000
    s_cbranch_scc1 Llw6
Llk7:
    s_add_u32 s93, s94, 6
    s_sub_u32 s85, s93, 7
    s_cmp_ge_u32 s93, 7
    s_cselect_b32 s93, s85, s93
    s_mul_i32 s93, s93, 229376
    s_add_u32 s93, s93, s49
    s_add_u32 m0, s53, 32768
    s_add_u32 s84, s93, 0
    buffer_load_dwordx4 v25, s[16:19], s84 offen  lds
    s_add_u32 m0, s53, 33792
    s_add_u32 s84, s93, 28672
    buffer_load_dwordx4 v26, s[16:19], s84 offen  lds
    s_add_u32 m0, s53, 34816
    s_add_u32 s84, s93, 57344
    buffer_load_dwordx4 v25, s[16:19], s84 offen  lds
    s_add_u32 m0, s53, 35840
    s_add_u32 s84, s93, 86016
    buffer_load_dwordx4 v26, s[16:19], s84 offen  lds
    s_add_u32 m0, s53, 36864
    s_add_u32 s84, s93, 14336
    buffer_load_dwordx4 v25, s[16:19], s84 offen  lds
    s_add_u32 m0, s53, 37888
    s_add_u32 s84, s93, 43008
    buffer_load_dwordx4 v26, s[16:19], s84 offen  lds
    s_add_u32 m0, s53, 38912
    s_add_u32 s84, s93, 71680
    buffer_load_dwordx4 v25, s[16:19], s84 offen  lds
    s_add_u32 m0, s53, 39936
    s_add_u32 s84, s93, 100352
    buffer_load_dwordx4 v26, s[16:19], s84 offen  lds
    s_waitcnt vmcnt(24)
    v_mov_b32 v18, 10
    ds_max_u32 v17, v18 offset:0
    s_add_u32 s93, s94, 6
    s_sub_u32 s85, s93, 7
    s_cmp_ge_u32 s93, 7
    s_cselect_b32 s93, s85, s93
    s_mul_i32 s93, s93, 128
    s_add_u32 s93, s93, s48
    s_add_u32 m0, s53, 98304
    s_add_u32 s84, s93, 0
    buffer_load_dwordx4 v24, s[8:11], s84 offen  lds
    s_add_u32 m0, s53, 99328
    s_add_u32 s84, s93, 7168
    buffer_load_dwordx4 v24, s[8:11], s84 offen  lds
    s_add_u32 m0, s53, 100352
    s_add_u32 s84, s93, 14336
    buffer_load_dwordx4 v24, s[8:11], s84 offen  lds
    s_add_u32 m0, s53, 101376
    s_add_u32 s84, s93, 21504
    buffer_load_dwordx4 v24, s[8:11], s84 offen  lds
    s_add_u32 m0, s53, 102400
    s_add_u32 s84, s93, 28672
    buffer_load_dwordx4 v24, s[8:11], s84 offen  lds
    s_add_u32 m0, s53, 103424
    s_add_u32 s84, s93, 35840
    buffer_load_dwordx4 v24, s[8:11], s84 offen  lds
    s_add_u32 m0, s53, 104448
    s_add_u32 s84, s93, 43008
    buffer_load_dwordx4 v24, s[8:11], s84 offen  lds
    s_add_u32 m0, s53, 105472
    s_add_u32 s84, s93, 50176
    buffer_load_dwordx4 v24, s[8:11], s84 offen  lds
    s_waitcnt vmcnt(0)
    v_mov_b32 v18, 14
    ds_max_u32 v17, v18 offset:0
Lnc8:
    ds_read_b64 v[6:7], v16 offset:64
    s_waitcnt lgkmcnt(0)
    v_readfirstlane_b32 s82, v6
    v_readfirstlane_b32 s83, v7
    s_cmp_lg_u32 s82, 0
    s_cbranch_scc1 Lnk9
    s_sleep 2
    s_add_u32 s92, s92, 1
    s_cmp_lt_u32 s92, 0x200000
    s_cbranch_scc1 Lnc8
Lnk9:
    s_mov_b32 s90, 9461760
    s_add_u32 s84, s90, 0
Lpl10:
    buffer_load_dwordx4 v[44:47], v2, s[20:23], s84 offen sc1
    buffer_load_dwordx4 v[48:51], v2, s[20:23], s84 offen offset:768 sc1
    s_waitcnt vmcnt(0)
    v_cmp_ne_u64 vcc, s[82:83], v[44:45]
    v_cmp_ne_u64 s[88:89], s[82:83], v[46:47]
    s_or_b64 vcc, vcc, s[88:89]
    v_cmp_ne_u64 s[88:89], s[82:83], v[48:49]
    s_or_b64 vcc, vcc, s[88:89]
    v_cmp_ne_u64 s[88:89], s[82:83], v[50:51]
    s_or_b64 vcc, vcc, s[88:89]
    s_cmp_eq_u64 vcc, 0
    s_cbranch_scc1 Lpk11
    s_sleep 8
    s_add_u32 s92, s92, 1
    s_cmp_lt_u32 s92, 0x200000
    s_cbranch_scc1 Lpl10
Lpk11:
    s_mov_b64 exec, -1
    s_cmp_lg_u32 s86, 0
    s_cbranch_scc1 Lw012
    s_lshl_b32 s84, s94, 7
    v_add_u32 v14, s84, v2
    v_subrev_u32 v15, 896, v14
    v_min_u32 v14, v14, v15
    s_mov_b32 m0, 145664
    s_mov_b32 exec_hi, 0xffffff
    buffer_load_dwordx4 v14, s[40:43], 0 offen lds
    s_mov_b32 exec_hi, -1
Lw012:
    ds_read_b128 v[20:23], v16 offset:16
    s_add_u32 s93, s94, 0
    s_sub_u32 s85, s93, 7
    s_cmp_ge_u32 s93, 7
    s_cselect_b32 s93, s85, s93
    s_mul_i32 s93, s93, 4096
    s_add_u32 s93, s93, s50
    s_add_u32 m0, s54, 131072
    s_add_u32 s84, s93, 9465856
    buffer_load_dwordx4 v27, s[20:23], s84 offen sc1 lds
    s_add_u32 m0, s54, 132096
    s_add_u32 s84, s93, 9466112
    buffer_load_dwordx4 v27, s[20:23], s84 offen sc1 lds
    s_add_u32 m0, s54, 135168
    s_add_u32 s84, s93, 9494528
    buffer_load_dwordx4 v27, s[20:23], s84 offen sc1 lds
    s_add_u32 m0, s54, 136192
    s_add_u32 s84, s93, 9494784
    buffer_load_dwordx4 v27, s[20:23], s84 offen sc1 lds
    s_add_u32 m0, s54, 139264
    s_add_u32 s84, s93, 9523200
    buffer_load_dwordx4 v27, s[20:23], s84 offen sc1 lds
    s_add_u32 m0, s54, 140288
    s_add_u32 s84, s93, 9523456
    buffer_load_dwordx4 v27, s[20:23], s84 offen sc1 lds
    s_add_u32 s93, s94, 0
    s_sub_u32 s85, s93, 7
    s_cmp_ge_u32 s93, 7
    s_cselect_b32 s93, s85, s93
    s_mul_i32 s93, s93, 128
    s_add_u32 s93, s93, s51
    s_add_u32 m0, s60, 143360
    s_add_u32 s84, s93, 0
    buffer_load_dwordx4 v24, s[8:11], s84 offen  lds
    s_waitcnt lgkmcnt(0)
    v_min3_u32 v20, v20, v21, v22
    v_min_u32 v20, v20, v23
    s_nop 0
    v_readfirstlane_b32 s85, v20
    s_cmp_ge_u32 s85, 5
    s_cbranch_scc1 Llk14
    s_waitcnt vmcnt(0)
    v_mov_b32 v18, 15
    ds_max_u32 v17, v18 offset:0
    ds_read_b128 v[20:23], v16 offset:16
    s_waitcnt lgkmcnt(0)
Llw13:
    v_min3_u32 v20, v20, v21, v22
    v_min_u32 v20, v20, v23
    s_nop 0
    v_readfirstlane_b32 s85, v20
    s_cmp_ge_u32 s85, 5
    s_cbranch_scc1 Llk14
    s_sleep 1
    ds_read_b128 v[20:23], v16 offset:16
    s_waitcnt lgkmcnt(0)
    s_add_u32 s92, s92, 1
    s_cmp_lt_u32 s92, 0x200000
    s_cbranch_scc1 Llw13
Llk14:
    s_add_u32 s93, s94, 1
    s_sub_u32 s85, s93, 7
    s_cmp_ge_u32 s93, 7
    s_cselect_b32 s93, s85, s93
    s_mul_i32 s93, s93, 4096
    s_add_u32 s93, s93, s50
    s_add_u32 m0, s54, 0
    s_add_u32 s84, s93, 9465856
    buffer_load_dwordx4 v27, s[20:23], s84 offen sc1 lds
    s_add_u32 m0, s54, 1024
    s_add_u32 s84, s93, 9466112
    buffer_load_dwordx4 v27, s[20:23], s84 offen sc1 lds
    s_add_u32 m0, s54, 4096
    s_add_u32 s84, s93, 9494528
    buffer_load_dwordx4 v27, s[20:23], s84 offen sc1 lds
    s_add_u32 m0, s54, 5120
    s_add_u32 s84, s93, 9494784
    buffer_load_dwordx4 v27, s[20:23], s84 offen sc1 lds
    s_add_u32 m0, s54, 8192
    s_add_u32 s84, s93, 9523200
    buffer_load_dwordx4 v27, s[20:23], s84 offen sc1 lds
    s_add_u32 m0, s54, 9216
    s_add_u32 s84, s93, 9523456
    buffer_load_dwordx4 v27, s[20:23], s84 offen sc1 lds
    s_add_u32 s93, s94, 1
    s_sub_u32 s85, s93, 7
    s_cmp_ge_u32 s93, 7
    s_cselect_b32 s93, s85, s93
    s_mul_i32 s93, s93, 128
    s_add_u32 s93, s93, s51
    s_add_u32 m0, s60, 12288
    s_add_u32 s84, s93, 0
    buffer_load_dwordx4 v24, s[8:11], s84 offen  lds
    ds_read_b128 v[20:23], v16 offset:16
    s_add_u32 s93, s94, 2
    s_sub_u32 s85, s93, 7
    s_cmp_ge_u32 s93, 7
    s_cselect_b32 s93, s85, s93
    s_mul_i32 s93, s93, 4096
    s_add_u32 s93, s93, s50
    s_add_u32 m0, s54, 65536
    s_add_u32 s84, s93, 9465856
    buffer_load_dwordx4 v27, s[20:23], s84 offen sc1 lds
    s_add_u32 m0, s54, 66560
    s_add_u32 s84, s93, 9466112
    buffer_load_dwordx4 v27, s[20:23], s84 offen sc1 lds
    s_add_u32 m0, s54, 69632
    s_add_u32 s84, s93, 9494528
    buffer_load_dwordx4 v27, s[20:23], s84 offen sc1 lds
    s_add_u32 m0, s54, 70656
    s_add_u32 s84, s93, 9494784
    buffer_load_dwordx4 v27, s[20:23], s84 offen sc1 lds
    s_add_u32 m0, s54, 73728
    s_add_u32 s84, s93, 9523200
    buffer_load_dwordx4 v27, s[20:23], s84 offen sc1 lds
    s_add_u32 m0, s54, 74752
    s_add_u32 s84, s93, 9523456
    buffer_load_dwordx4 v27, s[20:23], s84 offen sc1 lds
    s_add_u32 s93, s94, 2
    s_sub_u32 s85, s93, 7
    s_cmp_ge_u32 s93, 7
    s_cselect_b32 s93, s85, s93
    s_mul_i32 s93, s93, 128
    s_add_u32 s93, s93, s51
    s_add_u32 m0, s60, 77824
    s_add_u32 s84, s93, 0
    buffer_load_dwordx4 v24, s[8:11], s84 offen  lds
    s_waitcnt lgkmcnt(0)
    v_min3_u32 v20, v20, v21, v22
    v_min_u32 v20, v20, v23
    s_nop 0
    v_readfirstlane_b32 s85, v20
    s_cmp_ge_u32 s85, 6
    s_cbranch_scc1 Llk16
    s_waitcnt vmcnt(14)
    v_mov_b32 v18, 15
    ds_max_u32 v17, v18 offset:0
    ds_read_b128 v[20:23], v16 offset:16
    s_waitcnt lgkmcnt(0)
    v_min3_u32 v20, v20, v21, v22
    v_min_u32 v20, v20, v23
    s_nop 0
    v_readfirstlane_b32 s85, v20
    s_cmp_ge_u32 s85, 6
    s_cbranch_scc1 Llk16
    s_waitcnt vmcnt(7)
    v_mov_b32 v18, 16
    ds_max_u32 v17, v18 offset:0
    ds_read_b128 v[20:23], v16 offset:16
    s_waitcnt lgkmcnt(0)
    v_min3_u32 v20, v20, v21, v22
    v_min_u32 v20, v20, v23
    s_nop 0
    v_readfirstlane_b32 s85, v20
    s_cmp_ge_u32 s85, 6
    s_cbranch_scc1 Llk16
    s_waitcnt vmcnt(0)
    v_mov_b32 v18, 17
    ds_max_u32 v17, v18 offset:0
    ds_read_b128 v[20:23], v16 offset:16
    s_waitcnt lgkmcnt(0)
Llw15:
    v_min3_u32 v20, v20, v21, v22
    v_min_u32 v20, v20, v23
    s_nop 0
    v_readfirstlane_b32 s85, v20
    s_cmp_ge_u32 s85, 6
    s_cbranch_scc1 Llk16
    s_sleep 1
    ds_read_b128 v[20:23], v16 offset:16
    s_waitcnt lgkmcnt(0)
    s_add_u32 s92, s92, 1
    s_cmp_lt_u32 s92, 0x200000
    s_cbranch_scc1 Llw15
Llk16:
    s_add_u32 s93, s94, 3
    s_sub_u32 s85, s93, 7
    s_cmp_ge_u32 s93, 7
    s_cselect_b32 s93, s85, s93
    s_mul_i32 s93, s93, 4096
    s_add_u32 s93, s93, s50
    s_add_u32 m0, s54, 16384
    s_add_u32 s84, s93, 9465856
    buffer_load_dwordx4 v27, s[20:23], s84 offen sc1 lds
    s_add_u32 m0, s54, 17408
    s_add_u32 s84, s93, 9466112
    buffer_load_dwordx4 v27, s[20:23], s84 offen sc1 lds
    s_add_u32 m0, s54, 20480
    s_add_u32 s84, s93, 9494528
    buffer_load_dwordx4 v27, s[20:23], s84 offen sc1 lds
    s_add_u32 m0, s54, 21504
    s_add_u32 s84, s93, 9494784
    buffer_load_dwordx4 v27, s[20:23], s84 offen sc1 lds
    s_add_u32 m0, s54, 24576
    s_add_u32 s84, s93, 9523200
    buffer_load_dwordx4 v27, s[20:23], s84 offen sc1 lds
    s_add_u32 m0, s54, 25600
    s_add_u32 s84, s93, 9523456
    buffer_load_dwordx4 v27, s[20:23], s84 offen sc1 lds
    s_add_u32 s93, s94, 3
    s_sub_u32 s85, s93, 7
    s_cmp_ge_u32 s93, 7
    s_cselect_b32 s93, s85, s93
    s_mul_i32 s93, s93, 128
    s_add_u32 s93, s93, s51
    s_add_u32 m0, s60, 28672
    s_add_u32 s84, s93, 0
    buffer_load_dwordx4 v24, s[8:11], s84 offen  lds
    s_waitcnt vmcnt(21)
    v_mov_b32 v18, 15
    ds_max_u32 v17, v18 offset:0
    ds_read_b128 v[20:23], v16 offset:16
    s_add_u32 s93, s94, 4
    s_sub_u32 s85, s93, 7
    s_cmp_ge_u32 s93, 7
    s_cselect_b32 s93, s85, s93
    s_mul_i32 s93, s93, 4096
    s_add_u32 s93, s93, s50
    s_add_u32 m0, s54, 81920
    s_add_u32 s84, s93, 9465856
    buffer_load_dwordx4 v27, s[20:23], s84 offen sc1 lds
    s_add_u32 m0, s54, 82944
    s_add_u32 s84, s93, 9466112
    buffer_load_dwordx4 v27, s[20:23], s84 offen sc1 lds
    s_add_u32 m0, s54, 86016
    s_add_u32 s84, s93, 9494528
    buffer_load_dwordx4 v27, s[20:23], s84 offen sc1 lds
    s_add_u32 m0, s54, 87040
    s_add_u32 s84, s93, 9494784
    buffer_load_dwordx4 v27, s[20:23], s84 offen sc1 lds
    s_add_u32 m0, s54, 90112
    s_add_u32 s84, s93, 9523200
    buffer_load_dwordx4 v27, s[20:23], s84 offen sc1 lds
    s_add_u32 m0, s54, 91136
    s_add_u32 s84, s93, 9523456
    buffer_load_dwordx4 v27, s[20:23], s84 offen sc1 lds
    s_add_u32 s93, s94, 4
    s_sub_u32 s85, s93, 7
    s_cmp_ge_u32 s93, 7
    s_cselect_b32 s93, s85, s93
    s_mul_i32 s93, s93, 128
    s_add_u32 s93, s93, s51
    s_add_u32 m0, s60, 94208
    s_add_u32 s84, s93, 0
    buffer_load_dwordx4 v24, s[8:11], s84 offen  lds
    s_waitcnt vmcnt(21)
    v_mov_b32 v18, 16
    ds_max_u32 v17, v18 offset:0
    s_waitcnt lgkmcnt(1)
    v_min3_u32 v20, v20, v21, v22
    v_min_u32 v20, v20, v23
    s_nop 0
    v_readfirstlane_b32 s85, v20
    s_cmp_ge_u32 s85, 7
    s_cbranch_scc1 Llk18
    s_waitcnt vmcnt(14)
    v_mov_b32 v18, 17
    ds_max_u32 v17, v18 offset:0
    ds_read_b128 v[20:23], v16 offset:16
    s_waitcnt lgkmcnt(0)
    v_min3_u32 v20, v20, v21, v22
    v_min_u32 v20, v20, v23
    s_nop 0
    v_readfirstlane_b32 s85, v20
    s_cmp_ge_u32 s85, 7
    s_cbranch_scc1 Llk18
    s_waitcnt vmcnt(7)
    v_mov_b32 v18, 18
    ds_max_u32 v17, v18 offset:0
    ds_read_b128 v[20:23], v16 offset:16
    s_waitcnt lgkmcnt(0)
    v_min3_u32 v20, v20, v21, v22
    v_min_u32 v20, v20, v23
    s_nop 0
    v_readfirstlane_b32 s85, v20
    s_cmp_ge_u32 s85, 7
    s_cbranch_scc1 Llk18
    s_waitcnt vmcnt(0)
    v_mov_b32 v18, 19
    ds_max_u32 v17, v18 offset:0
    ds_read_b128 v[20:23], v16 offset:16
    s_waitcnt lgkmcnt(0)
Llw17:
    v_min3_u32 v20, v20, v21, v22
    v_min_u32 v20, v20, v23
    s_nop 0
    v_readfirstlane_b32 s85, v20
    s_cmp_ge_u32 s85, 7
    s_cbranch_scc1 Llk18
    s_sleep 1
    ds_read_b128 v[20:23], v16 offset:16
    s_waitcnt lgkmcnt(0)
    s_add_u32 s92, s92, 1
    s_cmp_lt_u32 s92, 0x200000
    s_cbranch_scc1 Llw17
Llk18:
    s_add_u32 s93, s94, 5
    s_sub_u32 s85, s93, 7
    s_cmp_ge_u32 s93, 7
    s_cselect_b32 s93, s85, s93
    s_mul_i32 s93, s93, 4096
    s_add_u32 s93, s93, s50
    s_add_u32 m0, s54, 32768
    s_add_u32 s84, s93, 9465856
    buffer_load_dwordx4 v27, s[20:23], s84 offen sc1 lds
    s_add_u32 m0, s54, 33792
    s_add_u32 s84, s93, 9466112
    buffer_load_dwordx4 v27, s[20:23], s84 offen sc1 lds
    s_add_u32 m0, s54, 36864
    s_add_u32 s84, s93, 9494528
    buffer_load_dwordx4 v27, s[20:23], s84 offen sc1 lds
    s_add_u32 m0, s54, 37888
    s_add_u32 s84, s93, 9494784
    buffer_load_dwordx4 v27, s[20:23], s84 offen sc1 lds
    s_add_u32 m0, s54, 40960
    s_add_u32 s84, s93, 9523200
    buffer_load_dwordx4 v27, s[20:23], s84 offen sc1 lds
    s_add_u32 m0, s54, 41984
    s_add_u32 s84, s93, 9523456
    buffer_load_dwordx4 v27, s[20:23], s84 offen sc1 lds
    s_add_u32 s93, s94, 5
    s_sub_u32 s85, s93, 7
    s_cmp_ge_u32 s93, 7
    s_cselect_b32 s93, s85, s93
    s_mul_i32 s93, s93, 128
    s_add_u32 s93, s93, s51
    s_add_u32 m0, s60, 45056
    s_add_u32 s84, s93, 0
    buffer_load_dwordx4 v24, s[8:11], s84 offen  lds
    s_waitcnt vmcnt(21)
    v_mov_b32 v18, 17
    ds_max_u32 v17, v18 offset:0
    s_add_u32 s93, s94, 6
    s_sub_u32 s85, s93, 7
    s_cmp_ge_u32 s93, 7
    s_cselect_b32 s93, s85, s93
    s_mul_i32 s93, s93, 4096
    s_add_u32 s93, s93, s50
    s_add_u32 m0, s54, 98304
    s_add_u32 s84, s93, 9465856
    buffer_load_dwordx4 v27, s[20:23], s84 offen sc1 lds
    s_add_u32 m0, s54, 99328
    s_add_u32 s84, s93, 9466112
    buffer_load_dwordx4 v27, s[20:23], s84 offen sc1 lds
    s_add_u32 m0, s54, 102400
    s_add_u32 s84, s93, 9494528
    buffer_load_dwordx4 v27, s[20:23], s84 offen sc1 lds
    s_add_u32 m0, s54, 103424
    s_add_u32 s84, s93, 9494784
    buffer_load_dwordx4 v27, s[20:23], s84 offen sc1 lds
    s_add_u32 m0, s54, 106496
    s_add_u32 s84, s93, 9523200
    buffer_load_dwordx4 v27, s[20:23], s84 offen sc1 lds
    s_add_u32 m0, s54, 107520
    s_add_u32 s84, s93, 9523456
    buffer_load_dwordx4 v27, s[20:23], s84 offen sc1 lds
    s_add_u32 s93, s94, 6
    s_sub_u32 s85, s93, 7
    s_cmp_ge_u32 s93, 7
    s_cselect_b32 s93, s85, s93
    s_mul_i32 s93, s93, 128
    s_add_u32 s93, s93, s51
    s_add_u32 m0, s60, 110592
    s_add_u32 s84, s93, 0
    buffer_load_dwordx4 v24, s[8:11], s84 offen  lds
    s_waitcnt vmcnt(21)
    v_mov_b32 v18, 18
    ds_max_u32 v17, v18 offset:0
    s_waitcnt vmcnt(0)
    v_mov_b32 v18, 21
    ds_max_u32 v17, v18 offset:0
    s_branch gated_mix__sliding_local_dilated__dense_activation_squared_relu__prompt_kernel_P2
gated_mix__sliding_local_dilated__dense_activation_squared_relu__prompt_kernel_S:
    v_lshlrev_b32 v5, 3, v1
    v_mov_b32 v4, 0
    v_mov_b32 v16, 146944
    v_and_b32 v12, 3, v1
    v_lshrrev_b32 v13, 2, v1
    s_and_b32 s6, s2, 7
    s_lshl_b32 s6, s6, 2
    s_bfe_u32 s85, s2, 0x20003
    s_add_u32 s6, s6, s85
    s_lshr_b32 s7, s2, 5
    s_mov_b32 s80, -1
    s_mov_b32 s81, 0
    s_mov_b32 s92, 0
    s_lshl_b32 s84, s86, 2
    s_add_u32 s84, s84, 146944
    v_lshlrev_b32 v17, 2, v1
    v_add_u32 v17, 146560, v17
    v_writelane_b32 v17, s84, 0
    s_waitcnt lgkmcnt(0)
    s_cmp_lg_u32 s2, 0
    s_cbranch_scc1 Ln019
    s_cmp_lg_u32 s86, 2
    s_cbranch_scc1 Ln019
    s_memrealtime s[82:83]
    s_waitcnt lgkmcnt(0)
    s_or_b32 s82, s82, 1
    v_mov_b32 v6, s82
    v_mov_b32 v7, s83
    s_mov_b64 exec, 1
    global_store_dwordx2 v4, v[6:7], s[68:69] sc1
    s_mov_b64 exec, -1
Ln019:
    s_mov_b32 s16, s56
    s_and_b32 s17, s57, 0xffff
    s_mov_b32 s18, 1605632
    s_mov_b32 s19, 0x20000
    s_mov_b32 s8, s48
    s_and_b32 s9, s49, 0xffff
    s_mov_b32 s10, 1835008
    s_mov_b32 s11, 0x20000
    s_mov_b32 s12, s50
    s_and_b32 s13, s51, 0xffff
    s_mov_b32 s14, 1204224
    s_mov_b32 s15, 0x20000
    s_mov_b32 s24, s52
    s_and_b32 s25, s53, 0xffff
    s_mov_b32 s26, 401408
    s_mov_b32 s27, 0x20000
    s_mov_b32 s28, s60
    s_and_b32 s29, s61, 0xffff
    s_mov_b32 s30, 1605632
    s_mov_b32 s31, 0x20000
    s_mov_b32 s40, s64
    s_and_b32 s41, s65, 0xffff
    s_mov_b32 s42, 896
    s_mov_b32 s43, 0x20000
    s_mov_b32 s44, s62
    s_and_b32 s45, s63, 0xffff
    s_mov_b32 s46, 896
    s_mov_b32 s47, 0x20000
    s_mov_b32 s32, s66
    s_and_b32 s33, s67, 0xffff
    s_mov_b32 s34, 1835008
    s_mov_b32 s35, 0x20000
    s_mov_b32 s20, s70
    s_and_b32 s21, s71, 0xffff
    s_mov_b32 s22, 11104256
    s_mov_b32 s23, 0x20000
    s_mov_b64 s[0:1], s[70:71]
    s_getpc_b64 s[88:89]
gated_mix__sliding_local_dilated__dense_activation_squared_relu__prompt_kernel_pc:
    s_sub_u32 s88, s88, gated_mix__sliding_local_dilated__dense_activation_squared_relu__prompt_kernel_pc-gated_mix__sliding_local_dilated__dense_activation_squared_relu__prompt_kernel
    s_subb_u32 s89, s89, 0
    s_bfe_u32 s84, s2, 0x40003
    s_lshl_b32 s84, s84, 1
    s_and_b32 s85, s86, 1
    s_add_u32 s84, s84, s85
    s_lshl_b32 s84, s84, 10
    v_add_u32 v14, s84, v2
    v_min_u32 v14, gated_mix__sliding_local_dilated__dense_activation_squared_relu__prompt_kernel_end-gated_mix__sliding_local_dilated__dense_activation_squared_relu__prompt_kernel-16, v14
    global_load_dwordx4 v[32:35], v14, s[88:89]
    s_barrier
    v_mul_u32_u24 v15, 896, v10
    v_and_b32 v14, 1, v9
    v_xor_b32 v14, v14, v11
    v_lshl_add_u32 v28, v14, 4, v15
    s_lshl_b32 s52, s86, 12
    s_lshl_b32 s84, s6, 8
    s_add_u32 s55, s84, 9445376
    s_mul_i32 s56, s6, 294912
    s_lshl_b32 s61, s7, 7
    s_mul_i32 s57, s86, 100352
    s_add_u32 s57, s57, s61
    s_mul_i32 s58, s86, 401408
    s_add_u32 s58, s58, s61
    s_mul_i32 s84, s86, 14336
    s_add_u32 s62, s56, s84
    s_add_u32 s63, s56, s52
    s_add_u32 s63, s63, 57344
    s_and_b32 s84, s6, 3
    s_mul_i32 s84, s84, 7
    s_add_u32 s84, s84, 1
    s_lshr_b32 s84, s84, 1
    s_lshl_b32 s85, s7, 1
    s_add_u32 s84, s84, s85
    s_sub_u32 s85, s84, 14
    s_cmp_ge_u32 s84, 14
    s_cselect_b32 s95, s85, s84
    s_add_u32 s84, s6, s7
    s_and_b32 s96, s84, 3
    v_lshlrev_b32 v26, 7, v1
    v_bfe_u32 v14, v1, 2, 1
    v_mul_u32_u24 v29, 2688, v14
    v_mul_u32_u24 v15, 56, v10
    v_add_u32 v29, v29, v15
    v_lshl_add_u32 v29, v12, 4, v29
    v_mul_u32_u24 v30, 86016, v10
    v_lshl_add_u32 v30, v11, 4, v30
    s_cmp_ge_u32 s2, 224
    s_cselect_b32 s84, 0x40000000, 0
    v_or_b32 v29, s84, v29
    v_or_b32 v30, s84, v30
    s_mul_i32 s84, s2, 5376
    s_and_b32 s85, s86, 1
    s_mul_i32 s85, s85, 1344
    s_add_u32 s84, s84, s85
    buffer_load_dwordx4 v[96:99], v29, s[12:15], s84 offen offset:0
    buffer_load_dwordx4 v[100:103], v29, s[12:15], s84 offen offset:448
    buffer_load_dwordx4 v[104:107], v29, s[12:15], s84 offen offset:896
    s_lshl_b32 s93, s2, 7
    s_add_u32 s93, s93, 9465856
    s_and_b32 s90, s86, 1
    s_waitcnt vmcnt(0)
    s_mul_i32 s84, s90, 716800
    s_add_u32 s84, s84, 0
    s_add_u32 s84, s84, s93
    buffer_store_dwordx4 v[96:99], v30, s[20:23], s84 offen sc1
    s_mul_i32 s84, s90, -630784
    s_add_u32 s84, s84, 688128
    s_add_u32 s84, s84, s93
    buffer_store_dwordx4 v[100:103], v30, s[20:23], s84 offen sc1
    s_mul_i32 s84, s90, 716800
    s_add_u32 s84, s84, 28672
    s_add_u32 s84, s84, s93
    buffer_store_dwordx4 v[104:107], v30, s[20:23], s84 offen sc1
    s_cmp_lg_u32 s86, 3
    s_cbranch_scc1 Lnw20
Lnf21:
    global_load_dwordx2 v[6:7], v4, s[68:69] sc1
    s_waitcnt vmcnt(0)
    v_readfirstlane_b32 s82, v6
    s_cmp_lg_u32 s82, 0
    s_cbranch_scc1 Lng22
    s_sleep 4
    s_add_u32 s92, s92, 1
    s_cmp_lt_u32 s92, 0x200000
    s_cbranch_scc1 Lnf21
Lng22:
    s_mov_b64 exec, 1
    ds_write_b64 v16, v[6:7] offset:64
    s_mov_b64 exec, -1
Lnw20:
    s_waitcnt vmcnt(0)
    v_mov_b32 v18, 1
    ds_max_u32 v17, v18 offset:48
Lnc23:
    ds_read_b64 v[6:7], v16 offset:64
    s_waitcnt lgkmcnt(0)
    v_readfirstlane_b32 s82, v6
    v_readfirstlane_b32 s83, v7
    s_cmp_lg_u32 s82, 0
    s_cbranch_scc1 Lnk24
    s_sleep 2
    s_add_u32 s92, s92, 1
    s_cmp_lt_u32 s92, 0x200000
    s_cbranch_scc1 Lnc23
Lnk24:
    s_cmp_lg_u32 s86, 2
    s_cbranch_scc1 Lrp25
    s_cmp_ge_u32 s2, 224
    s_cbranch_scc1 Lrp25
    ds_read_b128 v[20:23], v16 offset:48
    s_waitcnt lgkmcnt(0)
Llw26:
    v_min3_u32 v20, v20, v21, v22
    v_min_u32 v20, v20, v23
    s_nop 0
    v_readfirstlane_b32 s85, v20
    s_cmp_ge_u32 s85, 1
    s_cbranch_scc1 Llk27
    s_sleep 1
    ds_read_b128 v[20:23], v16 offset:48
    s_waitcnt lgkmcnt(0)
    s_add_u32 s92, s92, 1
    s_cmp_lt_u32 s92, 0x200000
    s_cbranch_scc1 Llw26
Llk27:
    s_lshl_b32 s59, s2, 3
    s_add_u32 s59, s59, 9461760
    v_mov_b32 v6, s82
    v_mov_b32 v7, s83
    s_add_u32 s84, s59, 0
    s_mov_b64 exec, 1
    buffer_store_dwordx2 v[6:7], v4, s[20:23], s84 offen sc1
    s_mov_b64 exec, -1
Lrp25:
    ds_read_b128 v[20:23], v16 offset:0
    s_waitcnt lgkmcnt(0)
Llw28:
    v_min3_u32 v20, v20, v21, v22
    v_min_u32 v20, v20, v23
    s_nop 0
    v_readfirstlane_b32 s85, v20
    s_cmp_ge_u32 s85, 8
    s_cbranch_scc1 Llk29
    s_sleep 1
    ds_read_b128 v[20:23], v16 offset:0
    s_waitcnt lgkmcnt(0)
    s_add_u32 s92, s92, 1
    s_cmp_lt_u32 s92, 0x200000
    s_cbranch_scc1 Llw28
Llk29:
    s_lshl_b32 s93, s2, 1
    s_and_b32 s85, s86, 1
    s_add_u32 s93, s93, s85
    s_mul_i32 s84, s93, 3200
    s_mov_b64 exec, 0x1ffffff
    buffer_load_dword v32, v26, s[28:31], s84 offen
    s_mul_i32 s84, s93, 896
    s_mov_b64 exec, 0x7f
    buffer_load_dword v32, v26, s[24:27], s84 offen
    s_mov_b64 exec, -1
    s_waitcnt vmcnt(0)
gated_mix__sliding_local_dilated__dense_activation_squared_relu__prompt_kernel_P2:
    s_cmp_ge_u32 s7, 7
    s_cbranch_scc1 gated_mix__sliding_local_dilated__dense_activation_squared_relu__prompt_kernel_lfin
    v_mov_b32 v56, v28
    v_add_u32 v57, 6144, v28
    v_add_u32 v58, 12288, v28
    v_add_u32 v59, 18432, v28
    v_mov_b32 v60, v2
    v_add_u32 v61, 73728, v2
    v_add_u32 v62, 147456, v2
    v_add_u32 v63, 221184, v2
    ds_read_b128 v[20:23], v16 offset:16
    s_waitcnt lgkmcnt(0)
Llw30:
    v_min3_u32 v20, v20, v21, v22
    v_min_u32 v20, v20, v23
    s_nop 0
    v_readfirstlane_b32 s85, v20
    s_cmp_ge_u32 s85, 5
    s_cbranch_scc1 Llk31
    s_sleep 1
    ds_read_b128 v[20:23], v16 offset:16
    s_waitcnt lgkmcnt(0)
    s_add_u32 s92, s92, 1
    s_cmp_lt_u32 s92, 0x200000
    s_cbranch_scc1 Llw30
Llk31:
    s_add_u32 s48, s95, 0
    s_sub_u32 s93, s48, 14
    s_min_u32 s48, s48, s93
    s_mul_i32 s48, s48, 28672
    s_add_u32 s48, s48, s58
    s_add_u32 m0, s52, 147456
    s_nop 0
    buffer_load_dwordx4 v56, s[28:31], s48 offen lds
    buffer_load_dwordx4 v57, s[28:31], s48 offen offset:1024 lds
    buffer_load_dwordx4 v58, s[28:31], s48 offen offset:2048 lds
    buffer_load_dwordx4 v59, s[28:31], s48 offen offset:3072 lds
    s_add_u32 s48, s95, 1
    s_sub_u32 s93, s48, 14
    s_min_u32 s48, s48, s93
    s_mul_i32 s48, s48, 28672
    s_add_u32 s48, s48, s58
    s_add_u32 m0, s52, 49152
    s_nop 0
    buffer_load_dwordx4 v56, s[28:31], s48 offen lds
    buffer_load_dwordx4 v57, s[28:31], s48 offen offset:1024 lds
    buffer_load_dwordx4 v58, s[28:31], s48 offen offset:2048 lds
    buffer_load_dwordx4 v59, s[28:31], s48 offen offset:3072 lds
    s_add_u32 s48, s95, 2
    s_sub_u32 s93, s48, 14
    s_min_u32 s48, s48, s93
    s_mul_i32 s48, s48, 28672
    s_add_u32 s48, s48, s58
    s_add_u32 m0, s52, 114688
    s_nop 0
    buffer_load_dwordx4 v56, s[28:31], s48 offen lds
    buffer_load_dwordx4 v57, s[28:31], s48 offen offset:1024 lds
    buffer_load_dwordx4 v58, s[28:31], s48 offen offset:2048 lds
    buffer_load_dwordx4 v59, s[28:31], s48 offen offset:3072 lds
    ds_read_b128 v[20:23], v16 offset:16
    s_waitcnt lgkmcnt(0)
Llw32:
    v_min3_u32 v20, v20, v21, v22
    v_min_u32 v20, v20, v23
    s_nop 0
    v_readfirstlane_b32 s85, v20
    s_cmp_ge_u32 s85, 9
    s_cbranch_scc1 Llk33
    s_sleep 1
    ds_read_b128 v[20:23], v16 offset:16
    s_waitcnt lgkmcnt(0)
    s_add_u32 s92, s92, 1
    s_cmp_lt_u32 s92, 0x200000
    s_cbranch_scc1 Llw32
Llk33:
    s_add_u32 s48, s95, 3
    s_sub_u32 s93, s48, 14
    s_min_u32 s48, s48, s93
    s_mul_i32 s48, s48, 28672
    s_add_u32 s48, s48, s58
    s_add_u32 m0, s52, 0
    s_nop 0
    buffer_load_dwordx4 v56, s[28:31], s48 offen lds
    buffer_load_dwordx4 v57, s[28:31], s48 offen offset:1024 lds
    buffer_load_dwordx4 v58, s[28:31], s48 offen offset:2048 lds
    buffer_load_dwordx4 v59, s[28:31], s48 offen offset:3072 lds
    v_bfe_u32 v14, v1, 3, 1
    v_lshl_add_u32 v14, v12, 1, v14
    v_lshlrev_b32 v15, 7, v13
    v_lshl_add_u32 v15, v14, 4, v15
    s_lshl_b32 s59, s86, 6
    s_add_u32 s59, s59, s55
    s_add_u32 s84, s59, 0
    s_load_dwordx16 s[64:79], s[0:1], s84 glc
Lsp34:
    s_waitcnt lgkmcnt(0)
    s_cmp_eq_u64 s[64:65], s[82:83]
    s_cbranch_scc0 Lsr36
    s_cmp_eq_u64 s[66:67], s[82:83]
    s_cbranch_scc0 Lsr36
    s_cmp_eq_u64 s[68:69], s[82:83]
    s_cbranch_scc0 Lsr36
    s_cmp_eq_u64 s[70:71], s[82:83]
    s_cbranch_scc0 Lsr36
    s_cmp_eq_u64 s[72:73], s[82:83]
    s_cbranch_scc0 Lsr36
    s_cmp_eq_u64 s[74:75], s[82:83]
    s_cbranch_scc0 Lsr36
    s_cmp_eq_u64 s[76:77], s[82:83]
    s_cbranch_scc0 Lsr36
    s_cmp_eq_u64 s[78:79], s[82:83]
    s_cbranch_scc0 Lsr36
    s_branch Lsk35
Lsr36:
    s_sleep 1
    s_add_u32 s84, s59, 0
    s_load_dwordx16 s[64:79], s[0:1], s84 glc
    s_add_u32 s92, s92, 1
    s_cmp_lt_u32 s92, 0x200000
    s_cbranch_scc1 Lsp34
    s_waitcnt lgkmcnt(0)
Lsk35:
    s_add_u32 s49, s95, 0
    s_sub_u32 s93, s49, 14
    s_min_u32 s49, s49, s93
    s_mul_i32 s49, s49, 1024
    s_add_u32 s49, s49, s62
    buffer_load_dwordx4 v[96:99], v60, s[20:23], s49 offen sc1
    buffer_load_dwordx4 v[100:103], v61, s[20:23], s49 offen sc1
    buffer_load_dwordx4 v[104:107], v62, s[20:23], s49 offen sc1
    buffer_load_dwordx4 v[108:111], v63, s[20:23], s49 offen sc1
    s_add_u32 s49, s95, 1
    s_sub_u32 s93, s49, 14
    s_min_u32 s49, s49, s93
    s_mul_i32 s49, s49, 1024
    s_add_u32 s49, s49, s62
    buffer_load_dwordx4 v[112:115], v60, s[20:23], s49 offen sc1
    buffer_load_dwordx4 v[116:119], v61, s[20:23], s49 offen sc1
    buffer_load_dwordx4 v[120:123], v62, s[20:23], s49 offen sc1
    buffer_load_dwordx4 v[124:127], v63, s[20:23], s49 offen sc1
    s_add_u32 s49, s95, 2
    s_sub_u32 s93, s49, 14
    s_min_u32 s49, s49, s93
    s_mul_i32 s49, s49, 1024
    s_add_u32 s49, s49, s62
    buffer_load_dwordx4 v[128:131], v60, s[20:23], s49 offen sc1
    buffer_load_dwordx4 v[132:135], v61, s[20:23], s49 offen sc1
    buffer_load_dwordx4 v[136:139], v62, s[20:23], s49 offen sc1
    buffer_load_dwordx4 v[140:143], v63, s[20:23], s49 offen sc1
    s_add_u32 s49, s95, 3
    s_sub_u32 s93, s49, 14
    s_min_u32 s49, s49, s93
    s_mul_i32 s49, s49, 1024
    s_add_u32 s49, s49, s62
    buffer_load_dwordx4 v[144:147], v60, s[20:23], s49 offen sc1
    buffer_load_dwordx4 v[148:151], v61, s[20:23], s49 offen sc1
    buffer_load_dwordx4 v[152:155], v62, s[20:23], s49 offen sc1
    buffer_load_dwordx4 v[156:159], v63, s[20:23], s49 offen sc1
    s_add_u32 s49, s95, 4
    s_sub_u32 s93, s49, 14
    s_min_u32 s49, s49, s93
    s_mul_i32 s49, s49, 1024
    s_add_u32 s49, s49, s62
    buffer_load_dwordx4 v[160:163], v60, s[20:23], s49 offen sc1
    buffer_load_dwordx4 v[164:167], v61, s[20:23], s49 offen sc1
    buffer_load_dwordx4 v[168:171], v62, s[20:23], s49 offen sc1
    buffer_load_dwordx4 v[172:175], v63, s[20:23], s49 offen sc1
    v_add_u32 v32, s52, v15
    v_xor_b32 v33, 16, v32
    v_add_u32 v34, 65536, v32
    v_add_u32 v35, 65536, v33
    v_add_u32 v36, 131072, v32
    v_add_u32 v37, 131072, v33
    v_lshlrev_b32 v15, 5, v9
    s_waitcnt vmcnt(32)
    ds_read_b64_tr_b16 v[64:65], v36 offset:16384
    ds_read_b64_tr_b16 v[66:67], v36 offset:18432
    ds_read_b64_tr_b16 v[68:69], v36 offset:16392
    ds_read_b64_tr_b16 v[70:71], v36 offset:18440
    ds_read_b64_tr_b16 v[72:73], v37 offset:16384
    ds_read_b64_tr_b16 v[74:75], v37 offset:18432
    ds_read_b64_tr_b16 v[76:77], v37 offset:16392
    ds_read_b64_tr_b16 v[78:79], v37 offset:18440
    s_waitcnt vmcnt(16)
    s_waitcnt lgkmcnt(6)
    v_mfma_f32_16x16x32_bf16 v[192:195], v[64:67], v[96:99], 0
    ds_read_b64_tr_b16 v[80:81], v32 offset:49152
    ds_read_b64_tr_b16 v[82:83], v32 offset:51200
    v_mfma_f32_16x16x32_bf16 v[208:211], v[64:67], v[100:103], 0
    ds_read_b64_tr_b16 v[84:85], v32 offset:49160
    ds_read_b64_tr_b16 v[86:87], v32 offset:51208
    ds_read_b64_tr_b16 v[88:89], v33 offset:49152
    v_mfma_f32_16x16x32_bf16 v[224:227], v[64:67], v[104:107], 0
    ds_read_b64_tr_b16 v[90:91], v33 offset:51200
    ds_read_b64_tr_b16 v[92:93], v33 offset:49160
    ds_read_b64_tr_b16 v[94:95], v33 offset:51208
    v_mfma_f32_16x16x32_bf16 v[240:243], v[64:67], v[108:111], 0
    s_add_u32 s49, s95, 5
    s_sub_u32 s93, s49, 14
    s_min_u32 s49, s49, s93
    s_mul_i32 s49, s49, 1024
    s_add_u32 s49, s49, s62
    s_waitcnt lgkmcnt(12)
    v_mfma_f32_16x16x32_bf16 v[196:199], v[68:71], v[96:99], 0
    buffer_load_dwordx4 v[176:179], v60, s[20:23], s49 offen sc1
    buffer_load_dwordx4 v[180:183], v61, s[20:23], s49 offen sc1
    buffer_load_dwordx4 v[184:187], v62, s[20:23], s49 offen sc1
    v_mfma_f32_16x16x32_bf16 v[212:215], v[68:71], v[100:103], 0
    buffer_load_dwordx4 v[188:191], v63, s[20:23], s49 offen sc1
    ds_read_b128 v[20:23], v16 offset:16
    s_waitcnt lgkmcnt(0)
Llw37:
    v_min3_u32 v20, v20, v21, v22
    v_min_u32 v20, v20, v23
    s_nop 0
    v_readfirstlane_b32 s85, v20
    s_cmp_ge_u32 s85, 10
    s_cbranch_scc1 Llk38
    s_sleep 1
    ds_read_b128 v[20:23], v16 offset:16
    s_waitcnt lgkmcnt(0)
    s_add_u32 s92, s92, 1
    s_cmp_lt_u32 s92, 0x200000
    s_cbranch_scc1 Llw37
Llk38:
    s_add_u32 s48, s95, 4
    s_sub_u32 s93, s48, 14
    v_mfma_f32_16x16x32_bf16 v[228:231], v[68:71], v[104:107], 0
    s_min_u32 s48, s48, s93
    s_mul_i32 s48, s48, 28672
    s_add_u32 s48, s48, s58
    s_add_u32 m0, s52, 65536
    s_nop 0
    buffer_load_dwordx4 v56, s[28:31], s48 offen lds
    v_mfma_f32_16x16x32_bf16 v[244:247], v[68:71], v[108:111], 0
    buffer_load_dwordx4 v57, s[28:31], s48 offen offset:1024 lds
    buffer_load_dwordx4 v58, s[28:31], s48 offen offset:2048 lds
    buffer_load_dwordx4 v59, s[28:31], s48 offen offset:3072 lds
    v_mfma_f32_16x16x32_bf16 v[200:203], v[72:75], v[96:99], 0
    v_mfma_f32_16x16x32_bf16 v[216:219], v[72:75], v[100:103], 0
    v_mfma_f32_16x16x32_bf16 v[232:235], v[72:75], v[104:107], 0
    v_mfma_f32_16x16x32_bf16 v[248:251], v[72:75], v[108:111], 0
    v_mfma_f32_16x16x32_bf16 v[204:207], v[76:79], v[96:99], 0
    v_mfma_f32_16x16x32_bf16 v[220:223], v[76:79], v[100:103], 0
    v_mfma_f32_16x16x32_bf16 v[236:239], v[76:79], v[104:107], 0
    v_mfma_f32_16x16x32_bf16 v[252:255], v[76:79], v[108:111], 0
    s_waitcnt vmcnt(20)
    v_mfma_f32_16x16x32_bf16 v[192:195], v[80:83], v[112:115], v[192:195]
    ds_read_b64_tr_b16 v[64:65], v34 offset:49152
    ds_read_b64_tr_b16 v[66:67], v34 offset:51200
    v_mfma_f32_16x16x32_bf16 v[208:211], v[80:83], v[116:119], v[208:211]
    ds_read_b64_tr_b16 v[68:69], v34 offset:49160
    ds_read_b64_tr_b16 v[70:71], v34 offset:51208
    ds_read_b64_tr_b16 v[72:73], v35 offset:49152
    v_mfma_f32_16x16x32_bf16 v[224:227], v[80:83], v[120:123], v[224:227]
    ds_read_b64_tr_b16 v[74:75], v35 offset:51200
    ds_read_b64_tr_b16 v[76:77], v35 offset:49160
    ds_read_b64_tr_b16 v[78:79], v35 offset:51208
    v_mfma_f32_16x16x32_bf16 v[240:243], v[80:83], v[124:127], v[240:243]
    s_add_u32 s49, s95, 6
    s_sub_u32 s93, s49, 14
    s_min_u32 s49, s49, s93
    s_mul_i32 s49, s49, 1024
    s_add_u32 s49, s49, s62
    v_mfma_f32_16x16x32_bf16 v[196:199], v[84:87], v[112:115], v[196:199]
    buffer_load_dwordx4 v[96:99], v60, s[20:23], s49 offen sc1
    buffer_load_dwordx4 v[100:103], v61, s[20:23], s49 offen sc1
    buffer_load_dwordx4 v[104:107], v62, s[20:23], s49 offen sc1
    v_mfma_f32_16x16x32_bf16 v[212:215], v[84:87], v[116:119], v[212:215]
    buffer_load_dwordx4 v[108:111], v63, s[20:23], s49 offen sc1
    ds_read_b128 v[20:23], v16 offset:16
    s_waitcnt lgkmcnt(0)
Llw39:
    v_min3_u32 v20, v20, v21, v22
    v_min_u32 v20, v20, v23
    s_nop 0
    v_readfirstlane_b32 s85, v20
    s_cmp_ge_u32 s85, 11
    s_cbranch_scc1 Llk40
    s_sleep 1
    ds_read_b128 v[20:23], v16 offset:16
    s_waitcnt lgkmcnt(0)
    s_add_u32 s92, s92, 1
    s_cmp_lt_u32 s92, 0x200000
    s_cbranch_scc1 Llw39
Llk40:
    s_add_u32 s48, s95, 5
    s_sub_u32 s93, s48, 14
    v_mfma_f32_16x16x32_bf16 v[228:231], v[84:87], v[120:123], v[228:231]
    s_min_u32 s48, s48, s93
    s_mul_i32 s48, s48, 28672
    s_add_u32 s48, s48, s58
    s_add_u32 m0, s52, 16384
    s_nop 0
    buffer_load_dwordx4 v56, s[28:31], s48 offen lds
    v_mfma_f32_16x16x32_bf16 v[244:247], v[84:87], v[124:127], v[244:247]
    buffer_load_dwordx4 v57, s[28:31], s48 offen offset:1024 lds
    buffer_load_dwordx4 v58, s[28:31], s48 offen offset:2048 lds
    buffer_load_dwordx4 v59, s[28:31], s48 offen offset:3072 lds
    v_mfma_f32_16x16x32_bf16 v[200:203], v[88:91], v[112:115], v[200:203]
    v_mfma_f32_16x16x32_bf16 v[216:219], v[88:91], v[116:119], v[216:219]
    v_mfma_f32_16x16x32_bf16 v[232:235], v[88:91], v[120:123], v[232:235]
    v_mfma_f32_16x16x32_bf16 v[248:251], v[88:91], v[124:127], v[248:251]
    v_mfma_f32_16x16x32_bf16 v[204:207], v[92:95], v[112:115], v[204:207]
    v_mfma_f32_16x16x32_bf16 v[220:223], v[92:95], v[116:119], v[220:223]
    v_mfma_f32_16x16x32_bf16 v[236:239], v[92:95], v[120:123], v[236:239]
    v_mfma_f32_16x16x32_bf16 v[252:255], v[92:95], v[124:127], v[252:255]
    s_waitcnt vmcnt(24)
    v_mfma_f32_16x16x32_bf16 v[192:195], v[64:67], v[128:131], v[192:195]
    ds_read_b64_tr_b16 v[80:81], v32 offset:0
    ds_read_b64_tr_b16 v[82:83], v32 offset:2048
    v_mfma_f32_16x16x32_bf16 v[208:211], v[64:67], v[132:135], v[208:211]
    ds_read_b64_tr_b16 v[84:85], v32 offset:8
    ds_read_b64_tr_b16 v[86:87], v32 offset:2056
    ds_read_b64_tr_b16 v[88:89], v33 offset:0
    v_mfma_f32_16x16x32_bf16 v[224:227], v[64:67], v[136:139], v[224:227]
    ds_read_b64_tr_b16 v[90:91], v33 offset:2048
    ds_read_b64_tr_b16 v[92:93], v33 offset:8
    ds_read_b64_tr_b16 v[94:95], v33 offset:2056
    v_mfma_f32_16x16x32_bf16 v[240:243], v[64:67], v[140:143], v[240:243]
    s_add_u32 s49, s95, 7
    s_sub_u32 s93, s49, 14
    s_min_u32 s49, s49, s93
    s_mul_i32 s49, s49, 1024
    s_add_u32 s49, s49, s62
    v_mfma_f32_16x16x32_bf16 v[196:199], v[68:71], v[128:131], v[196:199]
    buffer_load_dwordx4 v[112:115], v60, s[20:23], s49 offen sc1
    buffer_load_dwordx4 v[116:119], v61, s[20:23], s49 offen sc1
    buffer_load_dwordx4 v[120:123], v62, s[20:23], s49 offen sc1
    v_mfma_f32_16x16x32_bf16 v[212:215], v[68:71], v[132:135], v[212:215]
    buffer_load_dwordx4 v[124:127], v63, s[20:23], s49 offen sc1
    ds_read_b128 v[20:23], v16 offset:16
    s_waitcnt lgkmcnt(0)
Llw41:
    v_min3_u32 v20, v20, v21, v22
    v_min_u32 v20, v20, v23
    s_nop 0
    v_readfirstlane_b32 s85, v20
    s_cmp_ge_u32 s85, 12
    s_cbranch_scc1 Llk42
    s_sleep 1
    ds_read_b128 v[20:23], v16 offset:16
    s_waitcnt lgkmcnt(0)
    s_add_u32 s92, s92, 1
    s_cmp_lt_u32 s92, 0x200000
    s_cbranch_scc1 Llw41
Llk42:
    s_add_u32 s48, s95, 6
    s_sub_u32 s93, s48, 14
    v_mfma_f32_16x16x32_bf16 v[228:231], v[68:71], v[136:139], v[228:231]
    s_min_u32 s48, s48, s93
    s_mul_i32 s48, s48, 28672
    s_add_u32 s48, s48, s58
    s_add_u32 m0, s52, 81920
    s_nop 0
    buffer_load_dwordx4 v56, s[28:31], s48 offen lds
    v_mfma_f32_16x16x32_bf16 v[244:247], v[68:71], v[140:143], v[244:247]
    buffer_load_dwordx4 v57, s[28:31], s48 offen offset:1024 lds
    buffer_load_dwordx4 v58, s[28:31], s48 offen offset:2048 lds
    buffer_load_dwordx4 v59, s[28:31], s48 offen offset:3072 lds
    v_mfma_f32_16x16x32_bf16 v[200:203], v[72:75], v[128:131], v[200:203]
    v_mfma_f32_16x16x32_bf16 v[216:219], v[72:75], v[132:135], v[216:219]
    v_mfma_f32_16x16x32_bf16 v[232:235], v[72:75], v[136:139], v[232:235]
    v_mfma_f32_16x16x32_bf16 v[248:251], v[72:75], v[140:143], v[248:251]
    v_mfma_f32_16x16x32_bf16 v[204:207], v[76:79], v[128:131], v[204:207]
    v_mfma_f32_16x16x32_bf16 v[220:223], v[76:79], v[132:135], v[220:223]
    v_mfma_f32_16x16x32_bf16 v[236:239], v[76:79], v[136:139], v[236:239]
    v_mfma_f32_16x16x32_bf16 v[252:255], v[76:79], v[140:143], v[252:255]
    s_waitcnt vmcnt(28)
    v_mfma_f32_16x16x32_bf16 v[192:195], v[80:83], v[144:147], v[192:195]
    s_waitcnt vmcnt(16)
    ds_read_b64_tr_b16 v[64:65], v34 offset:0
    ds_read_b64_tr_b16 v[66:67], v34 offset:2048
    v_mfma_f32_16x16x32_bf16 v[208:211], v[80:83], v[148:151], v[208:211]
    ds_read_b64_tr_b16 v[68:69], v34 offset:8
    ds_read_b64_tr_b16 v[70:71], v34 offset:2056
    ds_read_b64_tr_b16 v[72:73], v35 offset:0
    v_mfma_f32_16x16x32_bf16 v[224:227], v[80:83], v[152:155], v[224:227]
    ds_read_b64_tr_b16 v[74:75], v35 offset:2048
    ds_read_b64_tr_b16 v[76:77], v35 offset:8
    ds_read_b64_tr_b16 v[78:79], v35 offset:2056
    v_mfma_f32_16x16x32_bf16 v[240:243], v[80:83], v[156:159], v[240:243]
    s_add_u32 s49, s95, 8
    s_sub_u32 s93, s49, 14
    s_min_u32 s49, s49, s93
    s_mul_i32 s49, s49, 1024
    s_add_u32 s49, s49, s62
    v_mfma_f32_16x16x32_bf16 v[196:199], v[84:87], v[144:147], v[196:199]
    buffer_load_dwordx4 v[128:131], v60, s[20:23], s49 offen sc1
    buffer_load_dwordx4 v[132:135], v61, s[20:23], s49 offen sc1
    buffer_load_dwordx4 v[136:139], v62, s[20:23], s49 offen sc1
    v_mfma_f32_16x16x32_bf16 v[212:215], v[84:87], v[148:151], v[212:215]
    buffer_load_dwordx4 v[140:143], v63, s[20:23], s49 offen sc1
    ds_read_b128 v[20:23], v16 offset:16
    s_waitcnt lgkmcnt(0)
Llw43:
    v_min3_u32 v20, v20, v21, v22
    v_min_u32 v20, v20, v23
    s_nop 0
    v_readfirstlane_b32 s85, v20
    s_cmp_ge_u32 s85, 13
    s_cbranch_scc1 Llk44
    s_sleep 1
    ds_read_b128 v[20:23], v16 offset:16
    s_waitcnt lgkmcnt(0)
    s_add_u32 s92, s92, 1
    s_cmp_lt_u32 s92, 0x200000
    s_cbranch_scc1 Llw43
Llk44:
    s_add_u32 s48, s95, 7
    s_sub_u32 s93, s48, 14
    v_mfma_f32_16x16x32_bf16 v[228:231], v[84:87], v[152:155], v[228:231]
    s_min_u32 s48, s48, s93
    s_mul_i32 s48, s48, 28672
    s_add_u32 s48, s48, s58
    s_add_u32 m0, s52, 32768
    s_nop 0
    buffer_load_dwordx4 v56, s[28:31], s48 offen lds
    v_mfma_f32_16x16x32_bf16 v[244:247], v[84:87], v[156:159], v[244:247]
    buffer_load_dwordx4 v57, s[28:31], s48 offen offset:1024 lds
    buffer_load_dwordx4 v58, s[28:31], s48 offen offset:2048 lds
    buffer_load_dwordx4 v59, s[28:31], s48 offen offset:3072 lds
    v_mfma_f32_16x16x32_bf16 v[200:203], v[88:91], v[144:147], v[200:203]
    v_mfma_f32_16x16x32_bf16 v[216:219], v[88:91], v[148:151], v[216:219]
    v_mfma_f32_16x16x32_bf16 v[232:235], v[88:91], v[152:155], v[232:235]
    v_mfma_f32_16x16x32_bf16 v[248:251], v[88:91], v[156:159], v[248:251]
    v_mfma_f32_16x16x32_bf16 v[204:207], v[92:95], v[144:147], v[204:207]
    v_mfma_f32_16x16x32_bf16 v[220:223], v[92:95], v[148:151], v[220:223]
    v_mfma_f32_16x16x32_bf16 v[236:239], v[92:95], v[152:155], v[236:239]
    v_mfma_f32_16x16x32_bf16 v[252:255], v[92:95], v[156:159], v[252:255]
    v_mfma_f32_16x16x32_bf16 v[192:195], v[64:67], v[160:163], v[192:195]
    s_waitcnt vmcnt(16)
    ds_read_b64_tr_b16 v[80:81], v32 offset:16384
    ds_read_b64_tr_b16 v[82:83], v32 offset:18432
    v_mfma_f32_16x16x32_bf16 v[208:211], v[64:67], v[164:167], v[208:211]
    ds_read_b64_tr_b16 v[84:85], v32 offset:16392
    ds_read_b64_tr_b16 v[86:87], v32 offset:18440
    ds_read_b64_tr_b16 v[88:89], v33 offset:16384
    v_mfma_f32_16x16x32_bf16 v[224:227], v[64:67], v[168:171], v[224:227]
    ds_read_b64_tr_b16 v[90:91], v33 offset:18432
    ds_read_b64_tr_b16 v[92:93], v33 offset:16392
    ds_read_b64_tr_b16 v[94:95], v33 offset:18440
    v_mfma_f32_16x16x32_bf16 v[240:243], v[64:67], v[172:175], v[240:243]
    s_add_u32 s49, s95, 9
    s_sub_u32 s93, s49, 14
    s_min_u32 s49, s49, s93
    s_mul_i32 s49, s49, 1024
    s_add_u32 s49, s49, s62
    v_mfma_f32_16x16x32_bf16 v[196:199], v[68:71], v[160:163], v[196:199]
    buffer_load_dwordx4 v[144:147], v60, s[20:23], s49 offen sc1
    buffer_load_dwordx4 v[148:151], v61, s[20:23], s49 offen sc1
    buffer_load_dwordx4 v[152:155], v62, s[20:23], s49 offen sc1
    v_mfma_f32_16x16x32_bf16 v[212:215], v[68:71], v[164:167], v[212:215]
    buffer_load_dwordx4 v[156:159], v63, s[20:23], s49 offen sc1
    ds_read_b128 v[20:23], v16 offset:16
    s_waitcnt lgkmcnt(0)
Llw45:
    v_min3_u32 v20, v20, v21, v22
    v_min_u32 v20, v20, v23
    s_nop 0
    v_readfirstlane_b32 s85, v20
    s_cmp_ge_u32 s85, 14
    s_cbranch_scc1 Llk46
    s_sleep 1
    ds_read_b128 v[20:23], v16 offset:16
    s_waitcnt lgkmcnt(0)
    s_add_u32 s92, s92, 1
    s_cmp_lt_u32 s92, 0x200000
    s_cbranch_scc1 Llw45
Llk46:
    s_add_u32 s48, s95, 8
    s_sub_u32 s93, s48, 14
    v_mfma_f32_16x16x32_bf16 v[228:231], v[68:71], v[168:171], v[228:231]
    s_min_u32 s48, s48, s93
    s_mul_i32 s48, s48, 28672
    s_add_u32 s48, s48, s58
    s_add_u32 m0, s52, 98304
    s_nop 0
    buffer_load_dwordx4 v56, s[28:31], s48 offen lds
    v_mfma_f32_16x16x32_bf16 v[244:247], v[68:71], v[172:175], v[244:247]
    buffer_load_dwordx4 v57, s[28:31], s48 offen offset:1024 lds
    buffer_load_dwordx4 v58, s[28:31], s48 offen offset:2048 lds
    buffer_load_dwordx4 v59, s[28:31], s48 offen offset:3072 lds
    v_mfma_f32_16x16x32_bf16 v[200:203], v[72:75], v[160:163], v[200:203]
    v_mfma_f32_16x16x32_bf16 v[216:219], v[72:75], v[164:167], v[216:219]
    v_mfma_f32_16x16x32_bf16 v[232:235], v[72:75], v[168:171], v[232:235]
    v_mfma_f32_16x16x32_bf16 v[248:251], v[72:75], v[172:175], v[248:251]
    v_mfma_f32_16x16x32_bf16 v[204:207], v[76:79], v[160:163], v[204:207]
    v_mfma_f32_16x16x32_bf16 v[220:223], v[76:79], v[164:167], v[220:223]
    v_mfma_f32_16x16x32_bf16 v[236:239], v[76:79], v[168:171], v[236:239]
    v_mfma_f32_16x16x32_bf16 v[252:255], v[76:79], v[172:175], v[252:255]
    v_mfma_f32_16x16x32_bf16 v[192:195], v[80:83], v[176:179], v[192:195]
    s_waitcnt vmcnt(16)
    ds_read_b64_tr_b16 v[64:65], v34 offset:16384
    ds_read_b64_tr_b16 v[66:67], v34 offset:18432
    v_mfma_f32_16x16x32_bf16 v[208:211], v[80:83], v[180:183], v[208:211]
    ds_read_b64_tr_b16 v[68:69], v34 offset:16392
    ds_read_b64_tr_b16 v[70:71], v34 offset:18440
    ds_read_b64_tr_b16 v[72:73], v35 offset:16384
    v_mfma_f32_16x16x32_bf16 v[224:227], v[80:83], v[184:187], v[224:227]
    ds_read_b64_tr_b16 v[74:75], v35 offset:18432
    ds_read_b64_tr_b16 v[76:77], v35 offset:16392
    ds_read_b64_tr_b16 v[78:79], v35 offset:18440
    v_mfma_f32_16x16x32_bf16 v[240:243], v[80:83], v[188:191], v[240:243]
    s_add_u32 s49, s95, 10
    s_sub_u32 s93, s49, 14
    s_min_u32 s49, s49, s93
    s_mul_i32 s49, s49, 1024
    s_add_u32 s49, s49, s62
    v_mfma_f32_16x16x32_bf16 v[196:199], v[84:87], v[176:179], v[196:199]
    buffer_load_dwordx4 v[160:163], v60, s[20:23], s49 offen sc1
    buffer_load_dwordx4 v[164:167], v61, s[20:23], s49 offen sc1
    buffer_load_dwordx4 v[168:171], v62, s[20:23], s49 offen sc1
    v_mfma_f32_16x16x32_bf16 v[212:215], v[84:87], v[180:183], v[212:215]
    buffer_load_dwordx4 v[172:175], v63, s[20:23], s49 offen sc1
    s_add_u32 s48, s95, 9
    s_sub_u32 s93, s48, 14
    s_min_u32 s48, s48, s93
    s_mul_i32 s48, s48, 28672
    v_mfma_f32_16x16x32_bf16 v[228:231], v[84:87], v[184:187], v[228:231]
    s_add_u32 s48, s48, s58
    s_add_u32 m0, s52, 147456
    s_nop 0
    buffer_load_dwordx4 v56, s[28:31], s48 offen lds
    buffer_load_dwordx4 v57, s[28:31], s48 offen offset:1024 lds
    v_mfma_f32_16x16x32_bf16 v[244:247], v[84:87], v[188:191], v[244:247]
    buffer_load_dwordx4 v58, s[28:31], s48 offen offset:2048 lds
    buffer_load_dwordx4 v59, s[28:31], s48 offen offset:3072 lds
    v_mfma_f32_16x16x32_bf16 v[200:203], v[88:91], v[176:179], v[200:203]
    v_mfma_f32_16x16x32_bf16 v[216:219], v[88:91], v[180:183], v[216:219]
    v_mfma_f32_16x16x32_bf16 v[232:235], v[88:91], v[184:187], v[232:235]
    v_mfma_f32_16x16x32_bf16 v[248:251], v[88:91], v[188:191], v[248:251]
    v_mfma_f32_16x16x32_bf16 v[204:207], v[92:95], v[176:179], v[204:207]
    v_mfma_f32_16x16x32_bf16 v[220:223], v[92:95], v[180:183], v[220:223]
    v_mfma_f32_16x16x32_bf16 v[236:239], v[92:95], v[184:187], v[236:239]
    v_mfma_f32_16x16x32_bf16 v[252:255], v[92:95], v[188:191], v[252:255]
    s_waitcnt lgkmcnt(6)
    v_mfma_f32_16x16x32_bf16 v[192:195], v[64:67], v[96:99], v[192:195]
    s_waitcnt vmcnt(16)
    ds_read_b64_tr_b16 v[80:81], v32 offset:32768
    ds_read_b64_tr_b16 v[82:83], v32 offset:34816
    v_mfma_f32_16x16x32_bf16 v[208:211], v[64:67], v[100:103], v[208:211]
    ds_read_b64_tr_b16 v[84:85], v32 offset:32776
    ds_read_b64_tr_b16 v[86:87], v32 offset:34824
    ds_read_b64_tr_b16 v[88:89], v33 offset:32768
    v_mfma_f32_16x16x32_bf16 v[224:227], v[64:67], v[104:107], v[224:227]
    ds_read_b64_tr_b16 v[90:91], v33 offset:34816
    ds_read_b64_tr_b16 v[92:93], v33 offset:32776
    ds_read_b64_tr_b16 v[94:95], v33 offset:34824
    v_mfma_f32_16x16x32_bf16 v[240:243], v[64:67], v[108:111], v[240:243]
    s_add_u32 s49, s95, 11
    s_sub_u32 s93, s49, 14
    s_min_u32 s49, s49, s93
    s_mul_i32 s49, s49, 1024
    s_add_u32 s49, s49, s62
    s_waitcnt lgkmcnt(12)
    v_mfma_f32_16x16x32_bf16 v[196:199], v[68:71], v[96:99], v[196:199]
    buffer_load_dwordx4 v[176:179], v60, s[20:23], s49 offen sc1
    buffer_load_dwordx4 v[180:183], v61, s[20:23], s49 offen sc1
    buffer_load_dwordx4 v[184:187], v62, s[20:23], s49 offen sc1
    v_mfma_f32_16x16x32_bf16 v[212:215], v[68:71], v[100:103], v[212:215]
    buffer_load_dwordx4 v[188:191], v63, s[20:23], s49 offen sc1
    s_add_u32 s48, s95, 10
    s_sub_u32 s93, s48, 14
    s_min_u32 s48, s48, s93
    s_mul_i32 s48, s48, 28672
    v_mfma_f32_16x16x32_bf16 v[228:231], v[68:71], v[104:107], v[228:231]
    s_add_u32 s48, s48, s58
    s_add_u32 m0, s52, 49152
    s_nop 0
    buffer_load_dwordx4 v56, s[28:31], s48 offen lds
    buffer_load_dwordx4 v57, s[28:31], s48 offen offset:1024 lds
    v_mfma_f32_16x16x32_bf16 v[244:247], v[68:71], v[108:111], v[244:247]
    buffer_load_dwordx4 v58, s[28:31], s48 offen offset:2048 lds
    buffer_load_dwordx4 v59, s[28:31], s48 offen offset:3072 lds
    s_waitcnt lgkmcnt(10)
    v_mfma_f32_16x16x32_bf16 v[200:203], v[72:75], v[96:99], v[200:203]
    v_mfma_f32_16x16x32_bf16 v[216:219], v[72:75], v[100:103], v[216:219]
    v_mfma_f32_16x16x32_bf16 v[232:235], v[72:75], v[104:107], v[232:235]
    v_mfma_f32_16x16x32_bf16 v[248:251], v[72:75], v[108:111], v[248:251]
    s_waitcnt lgkmcnt(8)
    v_mfma_f32_16x16x32_bf16 v[204:207], v[76:79], v[96:99], v[204:207]
    v_mfma_f32_16x16x32_bf16 v[220:223], v[76:79], v[100:103], v[220:223]
    v_mfma_f32_16x16x32_bf16 v[236:239], v[76:79], v[104:107], v[236:239]
    v_mfma_f32_16x16x32_bf16 v[252:255], v[76:79], v[108:111], v[252:255]
    s_waitcnt lgkmcnt(6)
    v_mfma_f32_16x16x32_bf16 v[192:195], v[80:83], v[112:115], v[192:195]
    s_waitcnt vmcnt(16)
    ds_read_b64_tr_b16 v[64:65], v34 offset:32768
    ds_read_b64_tr_b16 v[66:67], v34 offset:34816
    v_mfma_f32_16x16x32_bf16 v[208:211], v[80:83], v[116:119], v[208:211]
    ds_read_b64_tr_b16 v[68:69], v34 offset:32776
    ds_read_b64_tr_b16 v[70:71], v34 offset:34824
    ds_read_b64_tr_b16 v[72:73], v35 offset:32768
    v_mfma_f32_16x16x32_bf16 v[224:227], v[80:83], v[120:123], v[224:227]
    ds_read_b64_tr_b16 v[74:75], v35 offset:34816
    ds_read_b64_tr_b16 v[76:77], v35 offset:32776
    ds_read_b64_tr_b16 v[78:79], v35 offset:34824
    v_mfma_f32_16x16x32_bf16 v[240:243], v[80:83], v[124:127], v[240:243]
    s_add_u32 s49, s95, 12
    s_sub_u32 s93, s49, 14
    s_min_u32 s49, s49, s93
    s_mul_i32 s49, s49, 1024
    s_add_u32 s49, s49, s62
    s_waitcnt lgkmcnt(12)
    v_mfma_f32_16x16x32_bf16 v[196:199], v[84:87], v[112:115], v[196:199]
    buffer_load_dwordx4 v[96:99], v60, s[20:23], s49 offen sc1
    buffer_load_dwordx4 v[100:103], v61, s[20:23], s49 offen sc1
    buffer_load_dwordx4 v[104:107], v62, s[20:23], s49 offen sc1
    v_mfma_f32_16x16x32_bf16 v[212:215], v[84:87], v[116:119], v[212:215]
    buffer_load_dwordx4 v[108:111], v63, s[20:23], s49 offen sc1
    s_add_u32 s48, s95, 11
    s_sub_u32 s93, s48, 14
    s_min_u32 s48, s48, s93
    s_mul_i32 s48, s48, 28672
    v_mfma_f32_16x16x32_bf16 v[228:231], v[84:87], v[120:123], v[228:231]
    s_add_u32 s48, s48, s58
    s_add_u32 m0, s52, 114688
    s_nop 0
    buffer_load_dwordx4 v56, s[28:31], s48 offen lds
    buffer_load_dwordx4 v57, s[28:31], s48 offen offset:1024 lds
    v_mfma_f32_16x16x32_bf16 v[244:247], v[84:87], v[124:127], v[244:247]
    buffer_load_dwordx4 v58, s[28:31], s48 offen offset:2048 lds
    buffer_load_dwordx4 v59, s[28:31], s48 offen offset:3072 lds
    s_add_u32 s84, s59, 8192
    s_load_dwordx16 s[64:79], s[0:1], s84 glc
    s_add_u32 s84, s55, 8224
    s_load_dwordx4 s[88:91], s[0:1], s84 glc
    s_waitcnt lgkmcnt(10)
    v_mfma_f32_16x16x32_bf16 v[200:203], v[88:91], v[112:115], v[200:203]
    v_mfma_f32_16x16x32_bf16 v[216:219], v[88:91], v[116:119], v[216:219]
    v_mfma_f32_16x16x32_bf16 v[232:235], v[88:91], v[120:123], v[232:235]
    v_mfma_f32_16x16x32_bf16 v[248:251], v[88:91], v[124:127], v[248:251]
    s_waitcnt lgkmcnt(8)
    v_mfma_f32_16x16x32_bf16 v[204:207], v[92:95], v[112:115], v[204:207]
    v_mfma_f32_16x16x32_bf16 v[220:223], v[92:95], v[116:119], v[220:223]
    v_mfma_f32_16x16x32_bf16 v[236:239], v[92:95], v[120:123], v[236:239]
    v_mfma_f32_16x16x32_bf16 v[252:255], v[92:95], v[124:127], v[252:255]
    s_waitcnt lgkmcnt(6)
    v_mfma_f32_16x16x32_bf16 v[192:195], v[64:67], v[128:131], v[192:195]
    s_waitcnt vmcnt(16)
    ds_read_b64_tr_b16 v[80:81], v36 offset:16384
    ds_read_b64_tr_b16 v[82:83], v36 offset:18432
    v_mfma_f32_16x16x32_bf16 v[208:211], v[64:67], v[132:135], v[208:211]
    ds_read_b64_tr_b16 v[84:85], v36 offset:16392
    ds_read_b64_tr_b16 v[86:87], v36 offset:18440
    ds_read_b64_tr_b16 v[88:89], v37 offset:16384
    v_mfma_f32_16x16x32_bf16 v[224:227], v[64:67], v[136:139], v[224:227]
    ds_read_b64_tr_b16 v[90:91], v37 offset:18432
    ds_read_b64_tr_b16 v[92:93], v37 offset:16392
    ds_read_b64_tr_b16 v[94:95], v37 offset:18440
    v_mfma_f32_16x16x32_bf16 v[240:243], v[64:67], v[140:143], v[240:243]
    s_add_u32 s49, s95, 13
    s_sub_u32 s93, s49, 14
    s_min_u32 s49, s49, s93
    s_mul_i32 s49, s49, 1024
    s_add_u32 s49, s49, s62
    s_waitcnt lgkmcnt(12)
    v_mfma_f32_16x16x32_bf16 v[196:199], v[68:71], v[128:131], v[196:199]
    buffer_load_dwordx4 v[112:115], v60, s[20:23], s49 offen sc1
    buffer_load_dwordx4 v[116:119], v61, s[20:23], s49 offen sc1
    buffer_load_dwordx4 v[120:123], v62, s[20:23], s49 offen sc1
    v_mfma_f32_16x16x32_bf16 v[212:215], v[68:71], v[132:135], v[212:215]
    buffer_load_dwordx4 v[124:127], v63, s[20:23], s49 offen sc1
    s_add_u32 s48, s95, 12
    s_sub_u32 s93, s48, 14
    s_min_u32 s48, s48, s93
    s_mul_i32 s48, s48, 28672
    v_mfma_f32_16x16x32_bf16 v[228:231], v[68:71], v[136:139], v[228:231]
    s_add_u32 s48, s48, s58
    s_add_u32 m0, s52, 0
    s_nop 0
    buffer_load_dwordx4 v56, s[28:31], s48 offen lds
    buffer_load_dwordx4 v57, s[28:31], s48 offen offset:1024 lds
    v_mfma_f32_16x16x32_bf16 v[244:247], v[68:71], v[140:143], v[244:247]
    buffer_load_dwordx4 v58, s[28:31], s48 offen offset:2048 lds
    buffer_load_dwordx4 v59, s[28:31], s48 offen offset:3072 lds
    s_waitcnt lgkmcnt(10)
    v_mfma_f32_16x16x32_bf16 v[200:203], v[72:75], v[128:131], v[200:203]
    v_mfma_f32_16x16x32_bf16 v[216:219], v[72:75], v[132:135], v[216:219]
    v_mfma_f32_16x16x32_bf16 v[232:235], v[72:75], v[136:139], v[232:235]
    v_mfma_f32_16x16x32_bf16 v[248:251], v[72:75], v[140:143], v[248:251]
    s_waitcnt lgkmcnt(8)
    v_mfma_f32_16x16x32_bf16 v[204:207], v[76:79], v[128:131], v[204:207]
    v_mfma_f32_16x16x32_bf16 v[220:223], v[76:79], v[132:135], v[220:223]
    v_mfma_f32_16x16x32_bf16 v[236:239], v[76:79], v[136:139], v[236:239]
    v_mfma_f32_16x16x32_bf16 v[252:255], v[76:79], v[140:143], v[252:255]
    s_waitcnt lgkmcnt(6)
    v_mfma_f32_16x16x32_bf16 v[192:195], v[80:83], v[144:147], v[192:195]
    s_waitcnt vmcnt(16)
    ds_read_b64_tr_b16 v[64:65], v32 offset:49152
    ds_read_b64_tr_b16 v[66:67], v32 offset:51200
    v_mfma_f32_16x16x32_bf16 v[208:211], v[80:83], v[148:151], v[208:211]
    ds_read_b64_tr_b16 v[68:69], v32 offset:49160
    ds_read_b64_tr_b16 v[70:71], v32 offset:51208
    ds_read_b64_tr_b16 v[72:73], v33 offset:49152
    v_mfma_f32_16x16x32_bf16 v[224:227], v[80:83], v[152:155], v[224:227]
    ds_read_b64_tr_b16 v[74:75], v33 offset:51200
    ds_read_b64_tr_b16 v[76:77], v33 offset:49160
    ds_read_b64_tr_b16 v[78:79], v33 offset:51208
    v_mfma_f32_16x16x32_bf16 v[240:243], v[80:83], v[156:159], v[240:243]
Lsp47:
    s_waitcnt lgkmcnt(0)
    s_cmp_eq_u64 s[64:65], s[82:83]
    s_cbranch_scc0 Lsr49
    s_cmp_eq_u64 s[66:67], s[82:83]
    s_cbranch_scc0 Lsr49
    s_cmp_eq_u64 s[68:69], s[82:83]
    s_cbranch_scc0 Lsr49
    s_cmp_eq_u64 s[70:71], s[82:83]
    s_cbranch_scc0 Lsr49
    s_cmp_eq_u64 s[72:73], s[82:83]
    s_cbranch_scc0 Lsr49
    s_cmp_eq_u64 s[74:75], s[82:83]
    s_cbranch_scc0 Lsr49
    s_cmp_eq_u64 s[76:77], s[82:83]
    s_cbranch_scc0 Lsr49
    s_cmp_eq_u64 s[78:79], s[82:83]
    s_cbranch_scc0 Lsr49
    s_cmp_eq_u64 s[88:89], s[82:83]
    s_cbranch_scc0 Lsr49
    s_cmp_eq_u64 s[90:91], s[82:83]
    s_cbranch_scc0 Lsr49
    s_branch Lsk48
Lsr49:
    s_sleep 1
    s_add_u32 s84, s59, 8192
    s_load_dwordx16 s[64:79], s[0:1], s84 glc
    s_add_u32 s84, s55, 8224
    s_load_dwordx4 s[88:91], s[0:1], s84 glc
    s_add_u32 s92, s92, 1
    s_cmp_lt_u32 s92, 0x200000
    s_cbranch_scc1 Lsp47
    s_waitcnt lgkmcnt(0)
Lsk48:
    v_lshlrev_b32 v14, 2, v8
    s_lshl_b32 s84, s6, 8
    s_add_u32 s84, s84, 9437184
    buffer_load_dword v24, v14, s[20:23], s84 offen offset:0 sc1
    buffer_load_dword v25, v14, s[20:23], s84 offen offset:64 sc1
    buffer_load_dword v26, v14, s[20:23], s84 offen offset:128 sc1
    buffer_load_dword v27, v14, s[20:23], s84 offen offset:192 sc1
    buffer_load_dwordx4 v[48:51], v15, s[44:47], s61 offen
    buffer_load_dwordx4 v[52:55], v15, s[44:47], s61 offen offset:16
    s_add_u32 s49, s96, 0
    s_sub_u32 s93, s49, 4
    v_mfma_f32_16x16x32_bf16 v[196:199], v[84:87], v[144:147], v[196:199]
    s_min_u32 s49, s49, s93
    s_mul_i32 s49, s49, 1024
    s_add_u32 s49, s49, s63
    buffer_load_dwordx4 v[128:131], v60, s[20:23], s49 offen sc1
    v_mfma_f32_16x16x32_bf16 v[212:215], v[84:87], v[148:151], v[212:215]
    buffer_load_dwordx4 v[132:135], v61, s[20:23], s49 offen sc1
    buffer_load_dwordx4 v[136:139], v62, s[20:23], s49 offen sc1
    buffer_load_dwordx4 v[140:143], v63, s[20:23], s49 offen sc1
    v_mfma_f32_16x16x32_bf16 v[228:231], v[84:87], v[152:155], v[228:231]
    s_add_u32 s48, s95, 13
    s_sub_u32 s93, s48, 14
    s_min_u32 s48, s48, s93
    s_mul_i32 s48, s48, 28672
    s_add_u32 s48, s48, s58
    v_mfma_f32_16x16x32_bf16 v[244:247], v[84:87], v[156:159], v[244:247]
    s_add_u32 m0, s52, 65536
    s_nop 0
    buffer_load_dwordx4 v56, s[28:31], s48 offen lds
    buffer_load_dwordx4 v57, s[28:31], s48 offen offset:1024 lds
    buffer_load_dwordx4 v58, s[28:31], s48 offen offset:2048 lds
    v_mfma_f32_16x16x32_bf16 v[200:203], v[88:91], v[144:147], v[200:203]
    buffer_load_dwordx4 v59, s[28:31], s48 offen offset:3072 lds
    v_mfma_f32_16x16x32_bf16 v[216:219], v[88:91], v[148:151], v[216:219]
    v_mfma_f32_16x16x32_bf16 v[232:235], v[88:91], v[152:155], v[232:235]
    v_mfma_f32_16x16x32_bf16 v[248:251], v[88:91], v[156:159], v[248:251]
    v_mfma_f32_16x16x32_bf16 v[204:207], v[92:95], v[144:147], v[204:207]
    v_mfma_f32_16x16x32_bf16 v[220:223], v[92:95], v[148:151], v[220:223]
    v_mfma_f32_16x16x32_bf16 v[236:239], v[92:95], v[152:155], v[236:239]
    v_mfma_f32_16x16x32_bf16 v[252:255], v[92:95], v[156:159], v[252:255]
    v_mfma_f32_16x16x32_bf16 v[192:195], v[64:67], v[160:163], v[192:195]
    s_waitcnt vmcnt(22)
    ds_read_b64_tr_b16 v[80:81], v34 offset:49152
    ds_read_b64_tr_b16 v[82:83], v34 offset:51200
    v_mfma_f32_16x16x32_bf16 v[208:211], v[64:67], v[164:167], v[208:211]
    ds_read_b64_tr_b16 v[84:85], v34 offset:49160
    ds_read_b64_tr_b16 v[86:87], v34 offset:51208
    ds_read_b64_tr_b16 v[88:89], v35 offset:49152
    v_mfma_f32_16x16x32_bf16 v[224:227], v[64:67], v[168:171], v[224:227]
    ds_read_b64_tr_b16 v[90:91], v35 offset:51200
    ds_read_b64_tr_b16 v[92:93], v35 offset:49160
    ds_read_b64_tr_b16 v[94:95], v35 offset:51208
    v_mfma_f32_16x16x32_bf16 v[240:243], v[64:67], v[172:175], v[240:243]
    s_add_u32 s49, s96, 1
    s_sub_u32 s93, s49, 4
    s_min_u32 s49, s49, s93
    s_mul_i32 s49, s49, 1024
    s_add_u32 s49, s49, s63
    v_mfma_f32_16x16x32_bf16 v[196:199], v[68:71], v[160:163], v[196:199]
    buffer_load_dwordx4 v[144:147], v60, s[20:23], s49 offen sc1
    buffer_load_dwordx4 v[148:151], v61, s[20:23], s49 offen sc1
    buffer_load_dwordx4 v[152:155], v62, s[20:23], s49 offen sc1
    v_mfma_f32_16x16x32_bf16 v[212:215], v[68:71], v[164:167], v[212:215]
    buffer_load_dwordx4 v[156:159], v63, s[20:23], s49 offen sc1
    s_add_u32 s48, s96, 0
    s_sub_u32 s93, s48, 4
    s_min_u32 s48, s48, s93
    s_mul_i32 s48, s48, 25088
    v_mfma_f32_16x16x32_bf16 v[228:231], v[68:71], v[168:171], v[228:231]
    s_add_u32 s48, s48, s57
    s_add_u32 m0, s52, 16384
    s_nop 0
    buffer_load_dwordx4 v56, s[24:27], s48 offen lds
    buffer_load_dwordx4 v57, s[24:27], s48 offen offset:1024 lds
    v_mfma_f32_16x16x32_bf16 v[244:247], v[68:71], v[172:175], v[244:247]
    buffer_load_dwordx4 v58, s[24:27], s48 offen offset:2048 lds
    buffer_load_dwordx4 v59, s[24:27], s48 offen offset:3072 lds
    v_mfma_f32_16x16x32_bf16 v[200:203], v[72:75], v[160:163], v[200:203]
    v_mfma_f32_16x16x32_bf16 v[216:219], v[72:75], v[164:167], v[216:219]
    v_mfma_f32_16x16x32_bf16 v[232:235], v[72:75], v[168:171], v[232:235]
    v_mfma_f32_16x16x32_bf16 v[248:251], v[72:75], v[172:175], v[248:251]
    v_mfma_f32_16x16x32_bf16 v[204:207], v[76:79], v[160:163], v[204:207]
    v_mfma_f32_16x16x32_bf16 v[220:223], v[76:79], v[164:167], v[220:223]
    v_mfma_f32_16x16x32_bf16 v[236:239], v[76:79], v[168:171], v[236:239]
    v_mfma_f32_16x16x32_bf16 v[252:255], v[76:79], v[172:175], v[252:255]
    s_waitcnt lgkmcnt(6)
    v_mfma_f32_16x16x32_bf16 v[192:195], v[80:83], v[176:179], v[192:195]
    s_waitcnt vmcnt(22)
    ds_read_b64_tr_b16 v[64:65], v32 offset:0
    ds_read_b64_tr_b16 v[66:67], v32 offset:2048
    v_mfma_f32_16x16x32_bf16 v[208:211], v[80:83], v[180:183], v[208:211]
    ds_read_b64_tr_b16 v[68:69], v32 offset:8
    ds_read_b64_tr_b16 v[70:71], v32 offset:2056
    ds_read_b64_tr_b16 v[72:73], v33 offset:0
    v_mfma_f32_16x16x32_bf16 v[224:227], v[80:83], v[184:187], v[224:227]
    ds_read_b64_tr_b16 v[74:75], v33 offset:2048
    ds_read_b64_tr_b16 v[76:77], v33 offset:8
    ds_read_b64_tr_b16 v[78:79], v33 offset:2056
    v_mfma_f32_16x16x32_bf16 v[240:243], v[80:83], v[188:191], v[240:243]
    s_add_u32 s49, s96, 2
    s_sub_u32 s93, s49, 4
    s_min_u32 s49, s49, s93
    s_mul_i32 s49, s49, 1024
    s_add_u32 s49, s49, s63
    s_waitcnt lgkmcnt(12)
    v_mfma_f32_16x16x32_bf16 v[196:199], v[84:87], v[176:179], v[196:199]
    buffer_load_dwordx4 v[160:163], v60, s[20:23], s49 offen sc1
    buffer_load_dwordx4 v[164:167], v61, s[20:23], s49 offen sc1
    buffer_load_dwordx4 v[168:171], v62, s[20:23], s49 offen sc1
    v_mfma_f32_16x16x32_bf16 v[212:215], v[84:87], v[180:183], v[212:215]
    buffer_load_dwordx4 v[172:175], v63, s[20:23], s49 offen sc1
    s_add_u32 s48, s96, 1
    s_sub_u32 s93, s48, 4
    s_min_u32 s48, s48, s93
    s_mul_i32 s48, s48, 25088
    v_mfma_f32_16x16x32_bf16 v[228:231], v[84:87], v[184:187], v[228:231]
    s_add_u32 s48, s48, s57
    s_add_u32 m0, s52, 81920
    s_nop 0
    buffer_load_dwordx4 v56, s[24:27], s48 offen lds
    buffer_load_dwordx4 v57, s[24:27], s48 offen offset:1024 lds
    v_mfma_f32_16x16x32_bf16 v[244:247], v[84:87], v[188:191], v[244:247]
    buffer_load_dwordx4 v58, s[24:27], s48 offen offset:2048 lds
    buffer_load_dwordx4 v59, s[24:27], s48 offen offset:3072 lds
    s_waitcnt lgkmcnt(10)
    v_mfma_f32_16x16x32_bf16 v[200:203], v[88:91], v[176:179], v[200:203]
    v_mfma_f32_16x16x32_bf16 v[216:219], v[88:91], v[180:183], v[216:219]
    v_mfma_f32_16x16x32_bf16 v[232:235], v[88:91], v[184:187], v[232:235]
    v_mfma_f32_16x16x32_bf16 v[248:251], v[88:91], v[188:191], v[248:251]
    s_waitcnt lgkmcnt(8)
    v_mfma_f32_16x16x32_bf16 v[204:207], v[92:95], v[176:179], v[204:207]
    v_mfma_f32_16x16x32_bf16 v[220:223], v[92:95], v[180:183], v[220:223]
    v_mfma_f32_16x16x32_bf16 v[236:239], v[92:95], v[184:187], v[236:239]
    v_mfma_f32_16x16x32_bf16 v[252:255], v[92:95], v[188:191], v[252:255]
    s_waitcnt lgkmcnt(6)
    v_mfma_f32_16x16x32_bf16 v[192:195], v[64:67], v[96:99], v[192:195]
    s_waitcnt vmcnt(16)
    ds_read_b64_tr_b16 v[80:81], v34 offset:0
    ds_read_b64_tr_b16 v[82:83], v34 offset:2048
    v_mfma_f32_16x16x32_bf16 v[208:211], v[64:67], v[100:103], v[208:211]
    ds_read_b64_tr_b16 v[84:85], v34 offset:8
    ds_read_b64_tr_b16 v[86:87], v34 offset:2056
    ds_read_b64_tr_b16 v[88:89], v35 offset:0
    v_mfma_f32_16x16x32_bf16 v[224:227], v[64:67], v[104:107], v[224:227]
    ds_read_b64_tr_b16 v[90:91], v35 offset:2048
    ds_read_b64_tr_b16 v[92:93], v35 offset:8
    ds_read_b64_tr_b16 v[94:95], v35 offset:2056
    v_mfma_f32_16x16x32_bf16 v[240:243], v[64:67], v[108:111], v[240:243]
    s_add_u32 s49, s96, 3
    s_sub_u32 s93, s49, 4
    s_min_u32 s49, s49, s93
    s_mul_i32 s49, s49, 1024
    s_add_u32 s49, s49, s63
    s_waitcnt lgkmcnt(12)
    v_mfma_f32_16x16x32_bf16 v[196:199], v[68:71], v[96:99], v[196:199]
    buffer_load_dwordx4 v[176:179], v60, s[20:23], s49 offen sc1
    buffer_load_dwordx4 v[180:183], v61, s[20:23], s49 offen sc1
    buffer_load_dwordx4 v[184:187], v62, s[20:23], s49 offen sc1
    v_mfma_f32_16x16x32_bf16 v[212:215], v[68:71], v[100:103], v[212:215]
    buffer_load_dwordx4 v[188:191], v63, s[20:23], s49 offen sc1
    s_add_u32 s48, s96, 2
    s_sub_u32 s93, s48, 4
    s_min_u32 s48, s48, s93
    s_mul_i32 s48, s48, 25088
    v_mfma_f32_16x16x32_bf16 v[228:231], v[68:71], v[104:107], v[228:231]
    s_add_u32 s48, s48, s57
    s_add_u32 m0, s52, 32768
    s_nop 0
    buffer_load_dwordx4 v56, s[24:27], s48 offen lds
    buffer_load_dwordx4 v57, s[24:27], s48 offen offset:1024 lds
    v_mfma_f32_16x16x32_bf16 v[244:247], v[68:71], v[108:111], v[244:247]
    buffer_load_dwordx4 v58, s[24:27], s48 offen offset:2048 lds
    buffer_load_dwordx4 v59, s[24:27], s48 offen offset:3072 lds
    s_waitcnt lgkmcnt(10)
    v_mfma_f32_16x16x32_bf16 v[200:203], v[72:75], v[96:99], v[200:203]
    v_mfma_f32_16x16x32_bf16 v[216:219], v[72:75], v[100:103], v[216:219]
    v_mfma_f32_16x16x32_bf16 v[232:235], v[72:75], v[104:107], v[232:235]
    v_mfma_f32_16x16x32_bf16 v[248:251], v[72:75], v[108:111], v[248:251]
    s_waitcnt lgkmcnt(8)
    v_mfma_f32_16x16x32_bf16 v[204:207], v[76:79], v[96:99], v[204:207]
    v_mfma_f32_16x16x32_bf16 v[220:223], v[76:79], v[100:103], v[220:223]
    v_mfma_f32_16x16x32_bf16 v[236:239], v[76:79], v[104:107], v[236:239]
    v_mfma_f32_16x16x32_bf16 v[252:255], v[76:79], v[108:111], v[252:255]
    s_waitcnt lgkmcnt(6)
    v_mfma_f32_16x16x32_bf16 v[192:195], v[80:83], v[112:115], v[192:195]
    s_waitcnt vmcnt(16)
    ds_read_b64_tr_b16 v[64:65], v32 offset:16384
    ds_read_b64_tr_b16 v[66:67], v32 offset:18432
    v_mfma_f32_16x16x32_bf16 v[208:211], v[80:83], v[116:119], v[208:211]
    ds_read_b64_tr_b16 v[68:69], v32 offset:16392
    ds_read_b64_tr_b16 v[70:71], v32 offset:18440
    ds_read_b64_tr_b16 v[72:73], v33 offset:16384
    v_mfma_f32_16x16x32_bf16 v[224:227], v[80:83], v[120:123], v[224:227]
    ds_read_b64_tr_b16 v[74:75], v33 offset:18432
    ds_read_b64_tr_b16 v[76:77], v33 offset:16392
    ds_read_b64_tr_b16 v[78:79], v33 offset:18440
    v_mfma_f32_16x16x32_bf16 v[240:243], v[80:83], v[124:127], v[240:243]
    s_add_u32 s48, s96, 3
    s_sub_u32 s93, s48, 4
    s_min_u32 s48, s48, s93
    s_mul_i32 s48, s48, 25088
    s_add_u32 s48, s48, s57
    s_waitcnt lgkmcnt(12)
    v_mfma_f32_16x16x32_bf16 v[196:199], v[84:87], v[112:115], v[196:199]
    s_add_u32 m0, s52, 98304
    s_nop 0
    buffer_load_dwordx4 v56, s[24:27], s48 offen lds
    buffer_load_dwordx4 v57, s[24:27], s48 offen offset:1024 lds
    buffer_load_dwordx4 v58, s[24:27], s48 offen offset:2048 lds
    v_mfma_f32_16x16x32_bf16 v[212:215], v[84:87], v[116:119], v[212:215]
    buffer_load_dwordx4 v59, s[24:27], s48 offen offset:3072 lds
    v_mfma_f32_16x16x32_bf16 v[228:231], v[84:87], v[120:123], v[228:231]
    v_mfma_f32_16x16x32_bf16 v[244:247], v[84:87], v[124:127], v[244:247]
    s_waitcnt lgkmcnt(10)
    v_mfma_f32_16x16x32_bf16 v[200:203], v[88:91], v[112:115], v[200:203]
    v_mfma_f32_16x16x32_bf16 v[216:219], v[88:91], v[116:119], v[216:219]
    v_mfma_f32_16x16x32_bf16 v[232:235], v[88:91], v[120:123], v[232:235]
    v_mfma_f32_16x16x32_bf16 v[248:251], v[88:91], v[124:127], v[248:251]
    s_waitcnt lgkmcnt(8)
    v_mfma_f32_16x16x32_bf16 v[204:207], v[92:95], v[112:115], v[204:207]
    v_mfma_f32_16x16x32_bf16 v[220:223], v[92:95], v[116:119], v[220:223]
    v_mfma_f32_16x16x32_bf16 v[236:239], v[92:95], v[120:123], v[236:239]
    v_mfma_f32_16x16x32_bf16 v[252:255], v[92:95], v[124:127], v[252:255]
    v_sub_f32 v28, 1.0, v24
    v_sub_f32 v29, 1.0, v25
    v_sub_f32 v30, 1.0, v26
    v_sub_f32 v31, 1.0, v27
    v_lshlrev_b32 v40, 16, v48
    v_and_b32 v41, 0xffff0000, v48
    v_lshlrev_b32 v42, 16, v49
    v_and_b32 v43, 0xffff0000, v49
    v_lshlrev_b32 v44, 16, v50
    v_and_b32 v45, 0xffff0000, v50
    v_lshlrev_b32 v46, 16, v51
    v_and_b32 v47, 0xffff0000, v51
    v_lshlrev_b32 v48, 16, v52
    v_and_b32 v49, 0xffff0000, v52
    v_lshlrev_b32 v50, 16, v53
    v_and_b32 v51, 0xffff0000, v53
    v_lshlrev_b32 v52, 16, v54
    v_and_b32 v53, 0xffff0000, v54
    v_lshlrev_b32 v54, 16, v55
    v_and_b32 v55, 0xffff0000, v55
    v_pk_mul_f32 v[192:193], v[192:193], v[28:29] op_sel:[0,0] op_sel_hi:[1,0]
    v_pk_mul_f32 v[208:209], v[208:209], v[28:29] op_sel:[0,1] op_sel_hi:[1,1]
    v_pk_mul_f32 v[224:225], v[224:225], v[30:31] op_sel:[0,0] op_sel_hi:[1,0]
    v_pk_mul_f32 v[240:241], v[240:241], v[30:31] op_sel:[0,1] op_sel_hi:[1,1]
    v_pk_mul_f32 v[194:195], v[194:195], v[28:29] op_sel:[0,0] op_sel_hi:[1,0]
    v_pk_mul_f32 v[210:211], v[210:211], v[28:29] op_sel:[0,1] op_sel_hi:[1,1]
    v_pk_mul_f32 v[226:227], v[226:227], v[30:31] op_sel:[0,0] op_sel_hi:[1,0]
    v_pk_mul_f32 v[242:243], v[242:243], v[30:31] op_sel:[0,1] op_sel_hi:[1,1]
    v_pk_mul_f32 v[196:197], v[196:197], v[28:29] op_sel:[0,0] op_sel_hi:[1,0]
    v_pk_mul_f32 v[212:213], v[212:213], v[28:29] op_sel:[0,1] op_sel_hi:[1,1]
    v_pk_mul_f32 v[228:229], v[228:229], v[30:31] op_sel:[0,0] op_sel_hi:[1,0]
    v_pk_mul_f32 v[244:245], v[244:245], v[30:31] op_sel:[0,1] op_sel_hi:[1,1]
    v_pk_mul_f32 v[198:199], v[198:199], v[28:29] op_sel:[0,0] op_sel_hi:[1,0]
    v_pk_mul_f32 v[214:215], v[214:215], v[28:29] op_sel:[0,1] op_sel_hi:[1,1]
    v_pk_mul_f32 v[230:231], v[230:231], v[30:31] op_sel:[0,0] op_sel_hi:[1,0]
    v_pk_mul_f32 v[246:247], v[246:247], v[30:31] op_sel:[0,1] op_sel_hi:[1,1]
    v_pk_mul_f32 v[200:201], v[200:201], v[28:29] op_sel:[0,0] op_sel_hi:[1,0]
    v_pk_mul_f32 v[216:217], v[216:217], v[28:29] op_sel:[0,1] op_sel_hi:[1,1]
    v_pk_mul_f32 v[232:233], v[232:233], v[30:31] op_sel:[0,0] op_sel_hi:[1,0]
    v_pk_mul_f32 v[248:249], v[248:249], v[30:31] op_sel:[0,1] op_sel_hi:[1,1]
    v_pk_mul_f32 v[202:203], v[202:203], v[28:29] op_sel:[0,0] op_sel_hi:[1,0]
    v_pk_mul_f32 v[218:219], v[218:219], v[28:29] op_sel:[0,1] op_sel_hi:[1,1]
    v_pk_mul_f32 v[234:235], v[234:235], v[30:31] op_sel:[0,0] op_sel_hi:[1,0]
    v_pk_mul_f32 v[250:251], v[250:251], v[30:31] op_sel:[0,1] op_sel_hi:[1,1]
    v_pk_mul_f32 v[204:205], v[204:205], v[28:29] op_sel:[0,0] op_sel_hi:[1,0]
    v_pk_mul_f32 v[220:221], v[220:221], v[28:29] op_sel:[0,1] op_sel_hi:[1,1]
    v_pk_mul_f32 v[236:237], v[236:237], v[30:31] op_sel:[0,0] op_sel_hi:[1,0]
    v_pk_mul_f32 v[252:253], v[252:253], v[30:31] op_sel:[0,1] op_sel_hi:[1,1]
    v_pk_mul_f32 v[206:207], v[206:207], v[28:29] op_sel:[0,0] op_sel_hi:[1,0]
    v_pk_mul_f32 v[222:223], v[222:223], v[28:29] op_sel:[0,1] op_sel_hi:[1,1]
    v_pk_mul_f32 v[238:239], v[238:239], v[30:31] op_sel:[0,0] op_sel_hi:[1,0]
    v_pk_mul_f32 v[254:255], v[254:255], v[30:31] op_sel:[0,1] op_sel_hi:[1,1]
    s_nop 1
    s_waitcnt lgkmcnt(6)
    v_mfma_f32_16x16x32_bf16 v[192:195], v[64:67], v[128:131], v[192:195]
    s_waitcnt vmcnt(12)
    ds_read_b64_tr_b16 v[80:81], v34 offset:16384
    ds_read_b64_tr_b16 v[82:83], v34 offset:18432
    v_mfma_f32_16x16x32_bf16 v[208:211], v[64:67], v[132:135], v[208:211]
    ds_read_b64_tr_b16 v[84:85], v34 offset:16392
    ds_read_b64_tr_b16 v[86:87], v34 offset:18440
    ds_read_b64_tr_b16 v[88:89], v35 offset:16384
    v_mfma_f32_16x16x32_bf16 v[224:227], v[64:67], v[136:139], v[224:227]
    ds_read_b64_tr_b16 v[90:91], v35 offset:18432
    ds_read_b64_tr_b16 v[92:93], v35 offset:16392
    ds_read_b64_tr_b16 v[94:95], v35 offset:18440
    v_mfma_f32_16x16x32_bf16 v[240:243], v[64:67], v[140:143], v[240:243]
    s_waitcnt lgkmcnt(12)
    v_mfma_f32_16x16x32_bf16 v[196:199], v[68:71], v[128:131], v[196:199]
    v_mfma_f32_16x16x32_bf16 v[212:215], v[68:71], v[132:135], v[212:215]
    v_mfma_f32_16x16x32_bf16 v[228:231], v[68:71], v[136:139], v[228:231]
    v_mfma_f32_16x16x32_bf16 v[244:247], v[68:71], v[140:143], v[244:247]
    s_waitcnt lgkmcnt(10)
    v_mfma_f32_16x16x32_bf16 v[200:203], v[72:75], v[128:131], v[200:203]
    v_mfma_f32_16x16x32_bf16 v[216:219], v[72:75], v[132:135], v[216:219]
    v_mfma_f32_16x16x32_bf16 v[232:235], v[72:75], v[136:139], v[232:235]
    v_mfma_f32_16x16x32_bf16 v[248:251], v[72:75], v[140:143], v[248:251]
    s_waitcnt lgkmcnt(8)
    v_mfma_f32_16x16x32_bf16 v[204:207], v[76:79], v[128:131], v[204:207]
    v_mfma_f32_16x16x32_bf16 v[220:223], v[76:79], v[132:135], v[220:223]
    v_mfma_f32_16x16x32_bf16 v[236:239], v[76:79], v[136:139], v[236:239]
    v_mfma_f32_16x16x32_bf16 v[252:255], v[76:79], v[140:143], v[252:255]
    s_waitcnt lgkmcnt(6)
    v_mfma_f32_16x16x32_bf16 v[192:195], v[80:83], v[144:147], v[192:195]
    s_waitcnt vmcnt(4)
    ds_read_b64_tr_b16 v[64:65], v32 offset:32768
    ds_read_b64_tr_b16 v[66:67], v32 offset:34816
    v_mfma_f32_16x16x32_bf16 v[208:211], v[80:83], v[148:151], v[208:211]
    ds_read_b64_tr_b16 v[68:69], v32 offset:32776
    ds_read_b64_tr_b16 v[70:71], v32 offset:34824
    ds_read_b64_tr_b16 v[72:73], v33 offset:32768
    v_mfma_f32_16x16x32_bf16 v[224:227], v[80:83], v[152:155], v[224:227]
    ds_read_b64_tr_b16 v[74:75], v33 offset:34816
    ds_read_b64_tr_b16 v[76:77], v33 offset:32776
    ds_read_b64_tr_b16 v[78:79], v33 offset:34824
    v_mfma_f32_16x16x32_bf16 v[240:243], v[80:83], v[156:159], v[240:243]
    s_waitcnt lgkmcnt(12)
    v_mfma_f32_16x16x32_bf16 v[196:199], v[84:87], v[144:147], v[196:199]
    v_mfma_f32_16x16x32_bf16 v[212:215], v[84:87], v[148:151], v[212:215]
    v_mfma_f32_16x16x32_bf16 v[228:231], v[84:87], v[152:155], v[228:231]
    v_mfma_f32_16x16x32_bf16 v[244:247], v[84:87], v[156:159], v[244:247]
    s_waitcnt lgkmcnt(10)
    v_mfma_f32_16x16x32_bf16 v[200:203], v[88:91], v[144:147], v[200:203]
    v_mfma_f32_16x16x32_bf16 v[216:219], v[88:91], v[148:151], v[216:219]
    v_mfma_f32_16x16x32_bf16 v[232:235], v[88:91], v[152:155], v[232:235]
    v_mfma_f32_16x16x32_bf16 v[248:251], v[88:91], v[156:159], v[248:251]
    s_waitcnt lgkmcnt(8)
    v_mfma_f32_16x16x32_bf16 v[204:207], v[92:95], v[144:147], v[204:207]
    v_mfma_f32_16x16x32_bf16 v[220:223], v[92:95], v[148:151], v[220:223]
    v_mfma_f32_16x16x32_bf16 v[236:239], v[92:95], v[152:155], v[236:239]
    v_mfma_f32_16x16x32_bf16 v[252:255], v[92:95], v[156:159], v[252:255]
    s_waitcnt lgkmcnt(6)
    v_mfma_f32_16x16x32_bf16 v[192:195], v[64:67], v[160:163], v[192:195]
    s_waitcnt vmcnt(0)
    ds_read_b64_tr_b16 v[80:81], v34 offset:32768
    ds_read_b64_tr_b16 v[82:83], v34 offset:34816
    v_mfma_f32_16x16x32_bf16 v[208:211], v[64:67], v[164:167], v[208:211]
    ds_read_b64_tr_b16 v[84:85], v34 offset:32776
    ds_read_b64_tr_b16 v[86:87], v34 offset:34824
    ds_read_b64_tr_b16 v[88:89], v35 offset:32768
    v_mfma_f32_16x16x32_bf16 v[224:227], v[64:67], v[168:171], v[224:227]
    ds_read_b64_tr_b16 v[90:91], v35 offset:34816
    ds_read_b64_tr_b16 v[92:93], v35 offset:32776
    ds_read_b64_tr_b16 v[94:95], v35 offset:34824
    v_mfma_f32_16x16x32_bf16 v[240:243], v[64:67], v[172:175], v[240:243]
    s_waitcnt lgkmcnt(12)
    v_mfma_f32_16x16x32_bf16 v[196:199], v[68:71], v[160:163], v[196:199]
    v_mfma_f32_16x16x32_bf16 v[212:215], v[68:71], v[164:167], v[212:215]
    v_mfma_f32_16x16x32_bf16 v[228:231], v[68:71], v[168:171], v[228:231]
    v_mfma_f32_16x16x32_bf16 v[244:247], v[68:71], v[172:175], v[244:247]
    s_waitcnt lgkmcnt(10)
    v_mfma_f32_16x16x32_bf16 v[200:203], v[72:75], v[160:163], v[200:203]
    v_mfma_f32_16x16x32_bf16 v[216:219], v[72:75], v[164:167], v[216:219]
    v_mfma_f32_16x16x32_bf16 v[232:235], v[72:75], v[168:171], v[232:235]
    v_mfma_f32_16x16x32_bf16 v[248:251], v[72:75], v[172:175], v[248:251]
    s_waitcnt lgkmcnt(8)
    v_mfma_f32_16x16x32_bf16 v[204:207], v[76:79], v[160:163], v[204:207]
    v_mfma_f32_16x16x32_bf16 v[220:223], v[76:79], v[164:167], v[220:223]
    v_mfma_f32_16x16x32_bf16 v[236:239], v[76:79], v[168:171], v[236:239]
    v_mfma_f32_16x16x32_bf16 v[252:255], v[76:79], v[172:175], v[252:255]
    v_add_u32 v32, 147456, v2
    v_add_u32 v33, 49152, v2
    v_add_u32 v34, 114688, v2
    v_add_u32 v35, s52, v32
    v_add_u32 v36, s52, v33
    v_add_u32 v37, s52, v34
    s_waitcnt lgkmcnt(0)
    s_cmp_lg_u32 s86, 0
    s_cbranch_scc1 gated_mix__sliding_local_dilated__dense_activation_squared_relu__prompt_kernel_w1
    v_mfma_f32_16x16x32_bf16 v[208:211], v[80:83], v[180:183], v[208:211]
    v_mfma_f32_16x16x32_bf16 v[212:215], v[84:87], v[180:183], v[212:215]
    v_mfma_f32_16x16x32_bf16 v[216:219], v[88:91], v[180:183], v[216:219]
    v_mfma_f32_16x16x32_bf16 v[220:223], v[92:95], v[180:183], v[220:223]
    v_mfma_f32_16x16x32_bf16 v[224:227], v[80:83], v[184:187], v[224:227]
    v_mfma_f32_16x16x32_bf16 v[228:231], v[84:87], v[184:187], v[228:231]
    v_mfma_f32_16x16x32_bf16 v[232:235], v[88:91], v[184:187], v[232:235]
    v_mfma_f32_16x16x32_bf16 v[236:239], v[92:95], v[184:187], v[236:239]
    v_mfma_f32_16x16x32_bf16 v[240:243], v[80:83], v[188:191], v[240:243]
    ds_write_b128 v35, v[208:211] offset:0
    v_mfma_f32_16x16x32_bf16 v[244:247], v[84:87], v[188:191], v[244:247]
    ds_write_b128 v35, v[212:215] offset:1024
    v_mfma_f32_16x16x32_bf16 v[248:251], v[88:91], v[188:191], v[248:251]
    ds_write_b128 v35, v[216:219] offset:2048
    v_mfma_f32_16x16x32_bf16 v[252:255], v[92:95], v[188:191], v[252:255]
    ds_write_b128 v35, v[220:223] offset:3072
    v_mfma_f32_16x16x32_bf16 v[192:195], v[80:83], v[176:179], v[192:195]
    ds_write_b128 v36, v[224:227] offset:0
    v_mfma_f32_16x16x32_bf16 v[196:199], v[84:87], v[176:179], v[196:199]
    ds_write_b128 v36, v[228:231] offset:1024
    v_mfma_f32_16x16x32_bf16 v[200:203], v[88:91], v[176:179], v[200:203]
    ds_write_b128 v36, v[232:235] offset:2048
    v_mfma_f32_16x16x32_bf16 v[204:207], v[92:95], v[176:179], v[204:207]
    ds_write_b128 v36, v[236:239] offset:3072
    s_nop 3
    ds_write_b128 v37, v[240:243] offset:0
    ds_write_b128 v37, v[244:247] offset:1024
    ds_write_b128 v37, v[248:251] offset:2048
    ds_write_b128 v37, v[252:255] offset:3072
    s_nop 1
    v_fma_f32 v96, v28, v40, v192
    v_fma_f32 v97, v28, v41, v193
    v_fma_f32 v98, v28, v42, v194
    v_fma_f32 v99, v28, v43, v195
    v_fma_f32 v100, v28, v44, v196
    v_fma_f32 v101, v28, v45, v197
    v_fma_f32 v102, v28, v46, v198
    v_fma_f32 v103, v28, v47, v199
    v_fma_f32 v104, v28, v48, v200
    v_fma_f32 v105, v28, v49, v201
    v_fma_f32 v106, v28, v50, v202
    v_fma_f32 v107, v28, v51, v203
    v_fma_f32 v108, v28, v52, v204
    v_fma_f32 v109, v28, v53, v205
    v_fma_f32 v110, v28, v54, v206
    v_fma_f32 v111, v28, v55, v207
    s_waitcnt lgkmcnt(0)
    s_barrier
    ds_read_b128 v[112:115], v32 offset:12288
    ds_read_b128 v[116:119], v32 offset:13312
    ds_read_b128 v[120:123], v32 offset:14336
    ds_read_b128 v[124:127], v32 offset:15360
    ds_read_b128 v[128:131], v33 offset:8192
    ds_read_b128 v[132:135], v33 offset:9216
    ds_read_b128 v[136:139], v33 offset:10240
    ds_read_b128 v[140:143], v33 offset:11264
    ds_read_b128 v[144:147], v34 offset:4096
    ds_read_b128 v[148:151], v34 offset:5120
    ds_read_b128 v[152:155], v34 offset:6144
    ds_read_b128 v[156:159], v34 offset:7168
    s_branch gated_mix__sliding_local_dilated__dense_activation_squared_relu__prompt_kernel_wd
gated_mix__sliding_local_dilated__dense_activation_squared_relu__prompt_kernel_w1:
    s_cmp_lg_u32 s86, 1
    s_cbranch_scc1 gated_mix__sliding_local_dilated__dense_activation_squared_relu__prompt_kernel_w2
    v_mfma_f32_16x16x32_bf16 v[224:227], v[80:83], v[184:187], v[224:227]
    v_mfma_f32_16x16x32_bf16 v[228:231], v[84:87], v[184:187], v[228:231]
    v_mfma_f32_16x16x32_bf16 v[232:235], v[88:91], v[184:187], v[232:235]
    v_mfma_f32_16x16x32_bf16 v[236:239], v[92:95], v[184:187], v[236:239]
    v_mfma_f32_16x16x32_bf16 v[240:243], v[80:83], v[188:191], v[240:243]
    v_mfma_f32_16x16x32_bf16 v[244:247], v[84:87], v[188:191], v[244:247]
    v_mfma_f32_16x16x32_bf16 v[248:251], v[88:91], v[188:191], v[248:251]
    v_mfma_f32_16x16x32_bf16 v[252:255], v[92:95], v[188:191], v[252:255]
    v_mfma_f32_16x16x32_bf16 v[192:195], v[80:83], v[176:179], v[192:195]
    ds_write_b128 v35, v[224:227] offset:0
    v_mfma_f32_16x16x32_bf16 v[196:199], v[84:87], v[176:179], v[196:199]
    ds_write_b128 v35, v[228:231] offset:1024
    v_mfma_f32_16x16x32_bf16 v[200:203], v[88:91], v[176:179], v[200:203]
    ds_write_b128 v35, v[232:235] offset:2048
    v_mfma_f32_16x16x32_bf16 v[204:207], v[92:95], v[176:179], v[204:207]
    ds_write_b128 v35, v[236:239] offset:3072
    v_mfma_f32_16x16x32_bf16 v[208:211], v[80:83], v[180:183], v[208:211]
    ds_write_b128 v36, v[240:243] offset:0
    v_mfma_f32_16x16x32_bf16 v[212:215], v[84:87], v[180:183], v[212:215]
    ds_write_b128 v36, v[244:247] offset:1024
    v_mfma_f32_16x16x32_bf16 v[216:219], v[88:91], v[180:183], v[216:219]
    ds_write_b128 v36, v[248:251] offset:2048
    v_mfma_f32_16x16x32_bf16 v[220:223], v[92:95], v[180:183], v[220:223]
    ds_write_b128 v36, v[252:255] offset:3072
    s_nop 3
    ds_write_b128 v37, v[192:195] offset:0
    ds_write_b128 v37, v[196:199] offset:1024
    ds_write_b128 v37, v[200:203] offset:2048
    ds_write_b128 v37, v[204:207] offset:3072
    s_nop 1
    v_fma_f32 v96, v29, v40, v208
    v_fma_f32 v97, v29, v41, v209
    v_fma_f32 v98, v29, v42, v210
    v_fma_f32 v99, v29, v43, v211
    v_fma_f32 v100, v29, v44, v212
    v_fma_f32 v101, v29, v45, v213
    v_fma_f32 v102, v29, v46, v214
    v_fma_f32 v103, v29, v47, v215
    v_fma_f32 v104, v29, v48, v216
    v_fma_f32 v105, v29, v49, v217
    v_fma_f32 v106, v29, v50, v218
    v_fma_f32 v107, v29, v51, v219
    v_fma_f32 v108, v29, v52, v220
    v_fma_f32 v109, v29, v53, v221
    v_fma_f32 v110, v29, v54, v222
    v_fma_f32 v111, v29, v55, v223
    s_waitcnt lgkmcnt(0)
    s_barrier
    ds_read_b128 v[112:115], v32 offset:0
    ds_read_b128 v[116:119], v32 offset:1024
    ds_read_b128 v[120:123], v32 offset:2048
    ds_read_b128 v[124:127], v32 offset:3072
    ds_read_b128 v[128:131], v33 offset:12288
    ds_read_b128 v[132:135], v33 offset:13312
    ds_read_b128 v[136:139], v33 offset:14336
    ds_read_b128 v[140:143], v33 offset:15360
    ds_read_b128 v[144:147], v34 offset:8192
    ds_read_b128 v[148:151], v34 offset:9216
    ds_read_b128 v[152:155], v34 offset:10240
    ds_read_b128 v[156:159], v34 offset:11264
    s_branch gated_mix__sliding_local_dilated__dense_activation_squared_relu__prompt_kernel_wd
gated_mix__sliding_local_dilated__dense_activation_squared_relu__prompt_kernel_w2:
    s_cmp_lg_u32 s86, 2
    s_cbranch_scc1 gated_mix__sliding_local_dilated__dense_activation_squared_relu__prompt_kernel_w3
    v_mfma_f32_16x16x32_bf16 v[240:243], v[80:83], v[188:191], v[240:243]
    v_mfma_f32_16x16x32_bf16 v[244:247], v[84:87], v[188:191], v[244:247]
    v_mfma_f32_16x16x32_bf16 v[248:251], v[88:91], v[188:191], v[248:251]
    v_mfma_f32_16x16x32_bf16 v[252:255], v[92:95], v[188:191], v[252:255]
    v_mfma_f32_16x16x32_bf16 v[192:195], v[80:83], v[176:179], v[192:195]
    v_mfma_f32_16x16x32_bf16 v[196:199], v[84:87], v[176:179], v[196:199]
    v_mfma_f32_16x16x32_bf16 v[200:203], v[88:91], v[176:179], v[200:203]
    v_mfma_f32_16x16x32_bf16 v[204:207], v[92:95], v[176:179], v[204:207]
    v_mfma_f32_16x16x32_bf16 v[208:211], v[80:83], v[180:183], v[208:211]
    ds_write_b128 v35, v[240:243] offset:0
    v_mfma_f32_16x16x32_bf16 v[212:215], v[84:87], v[180:183], v[212:215]
    ds_write_b128 v35, v[244:247] offset:1024
    v_mfma_f32_16x16x32_bf16 v[216:219], v[88:91], v[180:183], v[216:219]
    ds_write_b128 v35, v[248:251] offset:2048
    v_mfma_f32_16x16x32_bf16 v[220:223], v[92:95], v[180:183], v[220:223]
    ds_write_b128 v35, v[252:255] offset:3072
    v_mfma_f32_16x16x32_bf16 v[224:227], v[80:83], v[184:187], v[224:227]
    ds_write_b128 v36, v[192:195] offset:0
    v_mfma_f32_16x16x32_bf16 v[228:231], v[84:87], v[184:187], v[228:231]
    ds_write_b128 v36, v[196:199] offset:1024
    v_mfma_f32_16x16x32_bf16 v[232:235], v[88:91], v[184:187], v[232:235]
    ds_write_b128 v36, v[200:203] offset:2048
    v_mfma_f32_16x16x32_bf16 v[236:239], v[92:95], v[184:187], v[236:239]
    ds_write_b128 v36, v[204:207] offset:3072
    s_nop 3
    ds_write_b128 v37, v[208:211] offset:0
    ds_write_b128 v37, v[212:215] offset:1024
    ds_write_b128 v37, v[216:219] offset:2048
    ds_write_b128 v37, v[220:223] offset:3072
    s_nop 1
    v_fma_f32 v96, v30, v40, v224
    v_fma_f32 v97, v30, v41, v225
    v_fma_f32 v98, v30, v42, v226
    v_fma_f32 v99, v30, v43, v227
    v_fma_f32 v100, v30, v44, v228
    v_fma_f32 v101, v30, v45, v229
    v_fma_f32 v102, v30, v46, v230
    v_fma_f32 v103, v30, v47, v231
    v_fma_f32 v104, v30, v48, v232
    v_fma_f32 v105, v30, v49, v233
    v_fma_f32 v106, v30, v50, v234
    v_fma_f32 v107, v30, v51, v235
    v_fma_f32 v108, v30, v52, v236
    v_fma_f32 v109, v30, v53, v237
    v_fma_f32 v110, v30, v54, v238
    v_fma_f32 v111, v30, v55, v239
    s_waitcnt lgkmcnt(0)
    s_barrier
    ds_read_b128 v[112:115], v32 offset:4096
    ds_read_b128 v[116:119], v32 offset:5120
    ds_read_b128 v[120:123], v32 offset:6144
    ds_read_b128 v[124:127], v32 offset:7168
    ds_read_b128 v[128:131], v33 offset:0
    ds_read_b128 v[132:135], v33 offset:1024
    ds_read_b128 v[136:139], v33 offset:2048
    ds_read_b128 v[140:143], v33 offset:3072
    ds_read_b128 v[144:147], v34 offset:12288
    ds_read_b128 v[148:151], v34 offset:13312
    ds_read_b128 v[152:155], v34 offset:14336
    ds_read_b128 v[156:159], v34 offset:15360
    s_branch gated_mix__sliding_local_dilated__dense_activation_squared_relu__prompt_kernel_wd
gated_mix__sliding_local_dilated__dense_activation_squared_relu__prompt_kernel_w3:
    v_mfma_f32_16x16x32_bf16 v[192:195], v[80:83], v[176:179], v[192:195]
    v_mfma_f32_16x16x32_bf16 v[196:199], v[84:87], v[176:179], v[196:199]
    v_mfma_f32_16x16x32_bf16 v[200:203], v[88:91], v[176:179], v[200:203]
    v_mfma_f32_16x16x32_bf16 v[204:207], v[92:95], v[176:179], v[204:207]
    v_mfma_f32_16x16x32_bf16 v[208:211], v[80:83], v[180:183], v[208:211]
    v_mfma_f32_16x16x32_bf16 v[212:215], v[84:87], v[180:183], v[212:215]
    v_mfma_f32_16x16x32_bf16 v[216:219], v[88:91], v[180:183], v[216:219]
    v_mfma_f32_16x16x32_bf16 v[220:223], v[92:95], v[180:183], v[220:223]
    v_mfma_f32_16x16x32_bf16 v[224:227], v[80:83], v[184:187], v[224:227]
    ds_write_b128 v35, v[192:195] offset:0
    v_mfma_f32_16x16x32_bf16 v[228:231], v[84:87], v[184:187], v[228:231]
    ds_write_b128 v35, v[196:199] offset:1024
    v_mfma_f32_16x16x32_bf16 v[232:235], v[88:91], v[184:187], v[232:235]
    ds_write_b128 v35, v[200:203] offset:2048
    v_mfma_f32_16x16x32_bf16 v[236:239], v[92:95], v[184:187], v[236:239]
    ds_write_b128 v35, v[204:207] offset:3072
    v_mfma_f32_16x16x32_bf16 v[240:243], v[80:83], v[188:191], v[240:243]
    ds_write_b128 v36, v[208:211] offset:0
    v_mfma_f32_16x16x32_bf16 v[244:247], v[84:87], v[188:191], v[244:247]
    ds_write_b128 v36, v[212:215] offset:1024
    v_mfma_f32_16x16x32_bf16 v[248:251], v[88:91], v[188:191], v[248:251]
    ds_write_b128 v36, v[216:219] offset:2048
    v_mfma_f32_16x16x32_bf16 v[252:255], v[92:95], v[188:191], v[252:255]
    ds_write_b128 v36, v[220:223] offset:3072
    s_nop 3
    ds_write_b128 v37, v[224:227] offset:0
    ds_write_b128 v37, v[228:231] offset:1024
    ds_write_b128 v37, v[232:235] offset:2048
    ds_write_b128 v37, v[236:239] offset:3072
    s_nop 1
    v_fma_f32 v96, v31, v40, v240
    v_fma_f32 v97, v31, v41, v241
    v_fma_f32 v98, v31, v42, v242
    v_fma_f32 v99, v31, v43, v243
    v_fma_f32 v100, v31, v44, v244
    v_fma_f32 v101, v31, v45, v245
    v_fma_f32 v102, v31, v46, v246
    v_fma_f32 v103, v31, v47, v247
    v_fma_f32 v104, v31, v48, v248
    v_fma_f32 v105, v31, v49, v249
    v_fma_f32 v106, v31, v50, v250
    v_fma_f32 v107, v31, v51, v251
    v_fma_f32 v108, v31, v52, v252
    v_fma_f32 v109, v31, v53, v253
    v_fma_f32 v110, v31, v54, v254
    v_fma_f32 v111, v31, v55, v255
    s_waitcnt lgkmcnt(0)
    s_barrier
    ds_read_b128 v[112:115], v32 offset:8192
    ds_read_b128 v[116:119], v32 offset:9216
    ds_read_b128 v[120:123], v32 offset:10240
    ds_read_b128 v[124:127], v32 offset:11264
    ds_read_b128 v[128:131], v33 offset:4096
    ds_read_b128 v[132:135], v33 offset:5120
    ds_read_b128 v[136:139], v33 offset:6144
    ds_read_b128 v[140:143], v33 offset:7168
    ds_read_b128 v[144:147], v34 offset:0
    ds_read_b128 v[148:151], v34 offset:1024
    ds_read_b128 v[152:155], v34 offset:2048
    ds_read_b128 v[156:159], v34 offset:3072
gated_mix__sliding_local_dilated__dense_activation_squared_relu__prompt_kernel_wd:
    v_mul_u32_u24 v14, 896, v8
    v_add_u32 v14, v14, v15
    s_lshl_b32 s84, s6, 6
    s_lshl_b32 s85, s86, 4
    s_add_u32 s84, s84, s85
    s_mul_i32 s84, s84, 896
    s_add_u32 s84, s84, s61
    s_waitcnt lgkmcnt(8)
    v_pk_add_f32 v[96:97], v[96:97], v[112:113]
    v_pk_add_f32 v[98:99], v[98:99], v[114:115]
    v_pk_add_f32 v[100:101], v[100:101], v[116:117]
    v_pk_add_f32 v[102:103], v[102:103], v[118:119]
    v_pk_add_f32 v[104:105], v[104:105], v[120:121]
    v_pk_add_f32 v[106:107], v[106:107], v[122:123]
    v_pk_add_f32 v[108:109], v[108:109], v[124:125]
    v_pk_add_f32 v[110:111], v[110:111], v[126:127]
    s_waitcnt lgkmcnt(4)
    v_pk_add_f32 v[96:97], v[96:97], v[128:129]
    v_pk_add_f32 v[98:99], v[98:99], v[130:131]
    v_pk_add_f32 v[100:101], v[100:101], v[132:133]
    v_pk_add_f32 v[102:103], v[102:103], v[134:135]
    v_pk_add_f32 v[104:105], v[104:105], v[136:137]
    v_pk_add_f32 v[106:107], v[106:107], v[138:139]
    v_pk_add_f32 v[108:109], v[108:109], v[140:141]
    v_pk_add_f32 v[110:111], v[110:111], v[142:143]
    s_waitcnt lgkmcnt(0)
    v_pk_add_f32 v[96:97], v[96:97], v[144:145]
    v_pk_add_f32 v[98:99], v[98:99], v[146:147]
    v_pk_add_f32 v[100:101], v[100:101], v[148:149]
    v_pk_add_f32 v[102:103], v[102:103], v[150:151]
    v_pk_add_f32 v[104:105], v[104:105], v[152:153]
    v_pk_add_f32 v[106:107], v[106:107], v[154:155]
    v_pk_add_f32 v[108:109], v[108:109], v[156:157]
    v_pk_add_f32 v[110:111], v[110:111], v[158:159]
    v_cvt_pk_bf16_f32 v64, v96, v97
    v_cvt_pk_bf16_f32 v65, v98, v99
    v_cvt_pk_bf16_f32 v66, v100, v101
    v_cvt_pk_bf16_f32 v67, v102, v103
    v_cvt_pk_bf16_f32 v68, v104, v105
    v_cvt_pk_bf16_f32 v69, v106, v107
    v_cvt_pk_bf16_f32 v70, v108, v109
    v_cvt_pk_bf16_f32 v71, v110, v111
    buffer_store_dwordx4 v[64:67], v14, s[32:35], s84 offen
    buffer_store_dwordx4 v[68:71], v14, s[32:35], s84 offen offset:16
gated_mix__sliding_local_dilated__dense_activation_squared_relu__prompt_kernel_lfin:
    s_endpgm
gated_mix__sliding_local_dilated__dense_activation_squared_relu__prompt_kernel_C:
    v_lshlrev_b32 v5, 3, v1
    v_mov_b32 v4, 0
    v_mov_b32 v16, 146944
    v_and_b32 v12, 3, v1
    v_lshrrev_b32 v13, 2, v1
    s_and_b32 s6, s2, 7
    s_lshl_b32 s6, s6, 2
    s_bfe_u32 s85, s2, 0x20003
    s_add_u32 s6, s6, s85
    s_lshr_b32 s7, s2, 5
    s_mov_b32 s80, -1
    s_mov_b32 s81, 0
    s_mov_b32 s92, 0
    s_lshl_b32 s84, s86, 2
    s_add_u32 s84, s84, 146944
    v_lshlrev_b32 v17, 2, v1
    v_add_u32 v17, 146560, v17
    v_writelane_b32 v17, s84, 0
    v_lshl_add_u32 v14, v1, 2, v16
    v_mov_b32 v15, 0
    s_mov_b64 vcc, 0x300c
    v_cndmask_b32 v15, v15, -1, vcc
    s_mov_b64 exec, 0x3ffff
    ds_write_b32 v14, v15
    s_mov_b64 exec, -1
    s_waitcnt lgkmcnt(0)
    s_barrier
    s_setprio 2
    v_lshlrev_b32 v15, 8, v13
    v_lshl_add_u32 v15, v12, 3, v15
    v_and_b32 v14, 7, v13
    v_lshl_add_u32 v24, v14, 5, v15
    s_and_b32 s84, s86, 1
    s_lshl_b32 s84, s84, 7
    v_xor_b32 v24, s84, v24
    v_xor_b32 v25, 32, v24
    v_xor_b32 v26, 64, v24
    v_xor_b32 v27, 96, v24
    v_xor_b32 v14, v9, v11
    v_lshlrev_b32 v15, 7, v8
    v_lshl_add_u32 v15, v14, 4, v15
    s_lshl_b32 s84, s86, 12
    s_add_u32 s85, s84, 65536
    v_add_u32 v28, s85, v15
    v_xor_b32 v29, 64, v28
    v_xor_b32 v30, 0x1000, v28
    v_xor_b32 v31, 64, v30
    v_lshlrev_b32 v34, 4, v9
    v_add_u32 v34, 145664, v34
    s_and_b32 s84, s86, 1
    s_lshl_b32 s84, s84, 7
    s_add_u32 s84, s84, 145408
    v_lshlrev_b32 v228, 3, v9
    v_add_u32 v228, s84, v228
    v_and_b32 v14, 1, v8
    v_cmp_eq_u32 s[72:73], 1, v14
    v_lshl_add_u32 v15, v9, 2, v14
    v_cmp_le_u32 s[74:75], v15, v8
    v_add_u32 v15, 2, v15
    v_cmp_le_u32 s[76:77], v15, v8
    s_mov_b32 s20, s70
    s_and_b32 s21, s71, 0xffff
    s_mov_b32 s22, 11104256
    s_mov_b32 s23, 0x20000
    s_or_b32 s84, s4, s86
    s_cmp_eq_u32 s84, 0
    s_cselect_b32 s78, -1, 0
    s_cselect_b32 s79, -1, 0
    s_lshl_b32 s84, s4, 3
    s_lshl_b32 s85, s86, 1
    s_add_u32 s84, s84, s85
    s_mul_i32 s48, s84, 73728
    s_lshl_b32 s50, s84, 6
    s_add_u32 s50, s50, 9437184
    s_xor_b32 s84, s84, 2
    s_mul_i32 s52, s84, 73728
    s_lshl_b32 s84, s87, 4
    s_and_b32 s85, s86, 1
    s_lshl_b32 s85, s85, 11
    s_add_u32 s84, s84, s85
    s_add_u32 s54, s48, s84
    s_add_u32 s55, s54, 73728
    s_add_u32 s56, s52, s84
    s_add_u32 s57, s56, 73728
    s_and_b32 s84, s5, 3
    s_lshl_b32 s84, s84, 1
    s_and_b32 s85, s86, 1
    s_add_u32 s84, s84, s85
    s_cmp_eq_u32 s84, 6
    s_cselect_b32 s85, 0x40000000, 0
    v_or_b32 v32, s85, v2
    s_cmp_eq_u32 s84, 5
    s_cselect_b32 s85, 0x40000000, 0
    v_or_b32 v33, s85, v2
    s_lshl_b32 s84, s5, 10
    s_add_u32 s51, s48, s84
    s_add_u32 s51, s51, 57344
    s_lshl_b32 s84, s4, 1
    s_lshr_b32 s85, s86, 1
    s_add_u32 s84, s84, s85
    s_lshl_b32 s84, s84, 4
    s_add_u32 s84, s84, s5
    s_lshl_b32 s84, s84, 1
    s_and_b32 s85, s86, 1
    s_add_u32 s84, s84, s85
    s_lshl_b32 s84, s84, 3
    s_add_u32 s49, s84, 9445376
    ds_read_b128 v[20:23], v16 offset:0
    s_waitcnt lgkmcnt(0)
Llw50:
    v_min3_u32 v20, v20, v21, v22
    v_min_u32 v20, v20, v23
    s_nop 0
    v_readfirstlane_b32 s85, v20
    s_cmp_ge_u32 s85, 2
    s_cbranch_scc1 Llk51
    s_sleep 1
    ds_read_b128 v[20:23], v16 offset:0
    s_waitcnt lgkmcnt(0)
    s_add_u32 s92, s92, 1
    s_cmp_lt_u32 s92, 0x200000
    s_cbranch_scc1 Llw50
Llk51:
    ds_read_b64 v[116:117], v228 offset:0
    ds_read_b64 v[118:119], v228 offset:32
    ds_read_b64 v[120:121], v228 offset:64
    ds_read_b64 v[122:123], v228 offset:96
    s_waitcnt lgkmcnt(0)
    v_lshlrev_b32 v132, 16, v116
    v_and_b32 v133, 0xffff0000, v116
    v_lshlrev_b32 v134, 16, v117
    v_and_b32 v135, 0xffff0000, v117
    v_lshlrev_b32 v136, 16, v118
    v_and_b32 v137, 0xffff0000, v118
    v_lshlrev_b32 v138, 16, v119
    v_and_b32 v139, 0xffff0000, v119
    v_lshlrev_b32 v140, 16, v120
    v_and_b32 v141, 0xffff0000, v120
    v_lshlrev_b32 v142, 16, v121
    v_and_b32 v143, 0xffff0000, v121
    v_lshlrev_b32 v144, 16, v122
    v_and_b32 v145, 0xffff0000, v122
    v_lshlrev_b32 v146, 16, v123
    v_and_b32 v147, 0xffff0000, v123
    ds_read_b128 v[52:55], v28 offset:0
    ds_read_b128 v[56:59], v28 offset:2048
    ds_read_b128 v[36:39], v30 offset:0
    ds_read_b128 v[40:43], v30 offset:2048
    ds_read_b64_tr_b16 v[228:229], v24 offset:0
    ds_read_b64_tr_b16 v[230:231], v24 offset:4096
    s_waitcnt lgkmcnt(0)
    v_mfma_f32_16x16x32_bf16 v[164:167], v[228:231], v[52:55], v[132:135]
    ds_read_b64_tr_b16 v[232:233], v25 offset:0
    ds_read_b64_tr_b16 v[234:235], v25 offset:4096
    v_mfma_f32_16x16x32_bf16 v[180:183], v[228:231], v[56:59], v[132:135]
    ds_read_b64_tr_b16 v[236:237], v26 offset:0
    ds_read_b64_tr_b16 v[238:239], v26 offset:4096
    v_mfma_f32_16x16x32_bf16 v[196:199], v[228:231], v[36:39], v[132:135]
    ds_read_b64_tr_b16 v[240:241], v27 offset:0
    ds_read_b64_tr_b16 v[242:243], v27 offset:4096
    v_mfma_f32_16x16x32_bf16 v[212:215], v[228:231], v[40:43], v[132:135]
    ds_read_b128 v[60:63], v29 offset:0
    ds_read_b128 v[64:67], v29 offset:2048
    s_waitcnt lgkmcnt(6)
    v_mfma_f32_16x16x32_bf16 v[168:171], v[232:235], v[52:55], v[136:139]
    ds_read_b128 v[44:47], v31 offset:0
    ds_read_b128 v[48:51], v31 offset:2048
    v_mfma_f32_16x16x32_bf16 v[184:187], v[232:235], v[56:59], v[136:139]
    ds_read_b64_tr_b16 v[244:245], v24 offset:8192
    ds_read_b64_tr_b16 v[246:247], v24 offset:12288
    v_mfma_f32_16x16x32_bf16 v[200:203], v[232:235], v[36:39], v[136:139]
    ds_read_b128 v[20:23], v16 offset:0
    ds_read_b64_tr_b16 v[248:249], v25 offset:8192
    v_mfma_f32_16x16x32_bf16 v[216:219], v[232:235], v[40:43], v[136:139]
    ds_read_b64_tr_b16 v[250:251], v25 offset:12288
    s_waitcnt lgkmcnt(11)
    v_mfma_f32_16x16x32_bf16 v[172:175], v[236:239], v[52:55], v[140:143]
    ds_read_b64_tr_b16 v[252:253], v26 offset:8192
    ds_read_b64_tr_b16 v[254:255], v26 offset:12288
    v_mfma_f32_16x16x32_bf16 v[188:191], v[236:239], v[56:59], v[140:143]
    v_mfma_f32_16x16x32_bf16 v[204:207], v[236:239], v[36:39], v[140:143]
    v_mfma_f32_16x16x32_bf16 v[220:223], v[236:239], v[40:43], v[140:143]
    s_waitcnt lgkmcnt(11)
    v_mfma_f32_16x16x32_bf16 v[176:179], v[240:243], v[52:55], v[144:147]
    ds_read_b64_tr_b16 v[228:229], v27 offset:8192
    ds_read_b64_tr_b16 v[230:231], v27 offset:12288
    v_mfma_f32_16x16x32_bf16 v[192:195], v[240:243], v[56:59], v[144:147]
    v_mfma_f32_16x16x32_bf16 v[208:211], v[240:243], v[36:39], v[144:147]
    v_mfma_f32_16x16x32_bf16 v[224:227], v[240:243], v[40:43], v[144:147]
    s_waitcnt lgkmcnt(7)
    v_mfma_f32_16x16x32_bf16 v[164:167], v[244:247], v[60:63], v[164:167]
    s_waitcnt lgkmcnt(6)
    v_min_u32 v20, v20, v21
    s_nop 0
    v_readfirstlane_b32 s85, v20
    s_cmp_ge_u32 s85, 4
    s_cbranch_scc0 Las52
Lak53:
    v_mfma_f32_16x16x32_bf16 v[180:183], v[244:247], v[64:67], v[180:183]
    ds_read_b128 v[68:71], v28 offset:16384
    ds_read_b128 v[72:75], v28 offset:18432
    v_mfma_f32_16x16x32_bf16 v[196:199], v[244:247], v[44:47], v[196:199]
    ds_read_b128 v[36:39], v30 offset:16384
    ds_read_b128 v[40:43], v30 offset:18432
    v_mfma_f32_16x16x32_bf16 v[212:215], v[244:247], v[48:51], v[212:215]
    ds_read_b64_tr_b16 v[232:233], v24 offset:16384
    ds_read_b64_tr_b16 v[234:235], v24 offset:20480
    s_waitcnt lgkmcnt(10)
    v_mfma_f32_16x16x32_bf16 v[168:171], v[248:251], v[60:63], v[168:171]
    ds_read_b64_tr_b16 v[236:237], v25 offset:16384
    ds_read_b64_tr_b16 v[238:239], v25 offset:20480
    v_mfma_f32_16x16x32_bf16 v[184:187], v[248:251], v[64:67], v[184:187]
    v_mfma_f32_16x16x32_bf16 v[200:203], v[248:251], v[44:47], v[200:203]
    v_mfma_f32_16x16x32_bf16 v[216:219], v[248:251], v[48:51], v[216:219]
    s_waitcnt lgkmcnt(10)
    v_mfma_f32_16x16x32_bf16 v[172:175], v[252:255], v[60:63], v[172:175]
    ds_read_b64_tr_b16 v[240:241], v26 offset:16384
    ds_read_b64_tr_b16 v[242:243], v26 offset:20480
    v_mfma_f32_16x16x32_bf16 v[188:191], v[252:255], v[64:67], v[188:191]
    v_mfma_f32_16x16x32_bf16 v[204:207], v[252:255], v[44:47], v[204:207]
    v_mfma_f32_16x16x32_bf16 v[220:223], v[252:255], v[48:51], v[220:223]
    s_waitcnt lgkmcnt(10)
    v_mfma_f32_16x16x32_bf16 v[176:179], v[228:231], v[60:63], v[176:179]
    ds_read_b64_tr_b16 v[244:245], v27 offset:16384
    ds_read_b64_tr_b16 v[246:247], v27 offset:20480
    v_mfma_f32_16x16x32_bf16 v[192:195], v[228:231], v[64:67], v[192:195]
    v_mfma_f32_16x16x32_bf16 v[208:211], v[228:231], v[44:47], v[208:211]
    v_mfma_f32_16x16x32_bf16 v[224:227], v[228:231], v[48:51], v[224:227]
    s_waitcnt lgkmcnt(6)
    v_mfma_f32_16x16x32_bf16 v[164:167], v[232:235], v[68:71], v[164:167]
    v_mov_b32 v18, 1
    ds_max_u32 v17, v18 offset:16
    ds_read_b128 v[76:79], v29 offset:16384
    v_mfma_f32_16x16x32_bf16 v[180:183], v[232:235], v[72:75], v[180:183]
    ds_read_b128 v[80:83], v29 offset:18432
    ds_read_b128 v[44:47], v31 offset:16384
    v_mfma_f32_16x16x32_bf16 v[196:199], v[232:235], v[36:39], v[196:199]
    ds_read_b128 v[48:51], v31 offset:18432
    ds_read_b64_tr_b16 v[248:249], v24 offset:24576
    v_mfma_f32_16x16x32_bf16 v[212:215], v[232:235], v[40:43], v[212:215]
    ds_read_b64_tr_b16 v[250:251], v24 offset:28672
    s_waitcnt lgkmcnt(11)
    v_mfma_f32_16x16x32_bf16 v[168:171], v[236:239], v[68:71], v[168:171]
    ds_read_b128 v[20:23], v16 offset:0
    ds_read_b64_tr_b16 v[252:253], v25 offset:24576
    v_mfma_f32_16x16x32_bf16 v[184:187], v[236:239], v[72:75], v[184:187]
    ds_read_b64_tr_b16 v[254:255], v25 offset:28672
    v_mfma_f32_16x16x32_bf16 v[200:203], v[236:239], v[36:39], v[200:203]
    v_mfma_f32_16x16x32_bf16 v[216:219], v[236:239], v[40:43], v[216:219]
    s_waitcnt lgkmcnt(12)
    v_mfma_f32_16x16x32_bf16 v[172:175], v[240:243], v[68:71], v[172:175]
    ds_read_b64_tr_b16 v[228:229], v26 offset:24576
    ds_read_b64_tr_b16 v[230:231], v26 offset:28672
    v_mfma_f32_16x16x32_bf16 v[188:191], v[240:243], v[72:75], v[188:191]
    v_mfma_f32_16x16x32_bf16 v[204:207], v[240:243], v[36:39], v[204:207]
    v_mfma_f32_16x16x32_bf16 v[220:223], v[240:243], v[40:43], v[220:223]
    s_waitcnt lgkmcnt(12)
    v_mfma_f32_16x16x32_bf16 v[176:179], v[244:247], v[68:71], v[176:179]
    ds_read_b64_tr_b16 v[232:233], v27 offset:24576
    ds_read_b64_tr_b16 v[234:235], v27 offset:28672
    v_mfma_f32_16x16x32_bf16 v[192:195], v[244:247], v[72:75], v[192:195]
    v_mfma_f32_16x16x32_bf16 v[208:211], v[244:247], v[36:39], v[208:211]
    v_mfma_f32_16x16x32_bf16 v[224:227], v[244:247], v[40:43], v[224:227]
    s_waitcnt lgkmcnt(7)
    v_mfma_f32_16x16x32_bf16 v[164:167], v[248:251], v[76:79], v[164:167]
    s_waitcnt lgkmcnt(6)
    v_min_u32 v20, v20, v21
    s_nop 0
    v_readfirstlane_b32 s85, v20
    s_cmp_ge_u32 s85, 6
    s_cbranch_scc0 Las54
Lak55:
    v_mfma_f32_16x16x32_bf16 v[180:183], v[248:251], v[80:83], v[180:183]
    ds_read_b128 v[84:87], v28 offset:32768
    ds_read_b128 v[88:91], v28 offset:34816
    v_mfma_f32_16x16x32_bf16 v[196:199], v[248:251], v[44:47], v[196:199]
    ds_read_b128 v[36:39], v30 offset:32768
    ds_read_b128 v[40:43], v30 offset:34816
    v_mfma_f32_16x16x32_bf16 v[212:215], v[248:251], v[48:51], v[212:215]
    ds_read_b64_tr_b16 v[236:237], v24 offset:32768
    ds_read_b64_tr_b16 v[238:239], v24 offset:36864
    s_waitcnt lgkmcnt(10)
    v_mfma_f32_16x16x32_bf16 v[168:171], v[252:255], v[76:79], v[168:171]
    ds_read_b64_tr_b16 v[240:241], v25 offset:32768
    ds_read_b64_tr_b16 v[242:243], v25 offset:36864
    v_mfma_f32_16x16x32_bf16 v[184:187], v[252:255], v[80:83], v[184:187]
    v_mfma_f32_16x16x32_bf16 v[200:203], v[252:255], v[44:47], v[200:203]
    v_mfma_f32_16x16x32_bf16 v[216:219], v[252:255], v[48:51], v[216:219]
    s_waitcnt lgkmcnt(10)
    v_mfma_f32_16x16x32_bf16 v[172:175], v[228:231], v[76:79], v[172:175]
    ds_read_b64_tr_b16 v[244:245], v26 offset:32768
    ds_read_b64_tr_b16 v[246:247], v26 offset:36864
    v_mfma_f32_16x16x32_bf16 v[188:191], v[228:231], v[80:83], v[188:191]
    v_mfma_f32_16x16x32_bf16 v[204:207], v[228:231], v[44:47], v[204:207]
    v_mfma_f32_16x16x32_bf16 v[220:223], v[228:231], v[48:51], v[220:223]
    s_waitcnt lgkmcnt(10)
    v_mfma_f32_16x16x32_bf16 v[176:179], v[232:235], v[76:79], v[176:179]
    ds_read_b64_tr_b16 v[248:249], v27 offset:32768
    ds_read_b64_tr_b16 v[250:251], v27 offset:36864
    v_mfma_f32_16x16x32_bf16 v[192:195], v[232:235], v[80:83], v[192:195]
    v_mfma_f32_16x16x32_bf16 v[208:211], v[232:235], v[44:47], v[208:211]
    v_mfma_f32_16x16x32_bf16 v[224:227], v[232:235], v[48:51], v[224:227]
    s_waitcnt lgkmcnt(6)
    v_mfma_f32_16x16x32_bf16 v[164:167], v[236:239], v[84:87], v[164:167]
    v_mov_b32 v18, 2
    ds_max_u32 v17, v18 offset:16
    ds_read_b128 v[92:95], v29 offset:32768
    v_mfma_f32_16x16x32_bf16 v[180:183], v[236:239], v[88:91], v[180:183]
    ds_read_b128 v[96:99], v29 offset:34816
    ds_read_b128 v[44:47], v31 offset:32768
    v_mfma_f32_16x16x32_bf16 v[196:199], v[236:239], v[36:39], v[196:199]
    ds_read_b128 v[48:51], v31 offset:34816
    ds_read_b64_tr_b16 v[252:253], v24 offset:40960
    v_mfma_f32_16x16x32_bf16 v[212:215], v[236:239], v[40:43], v[212:215]
    ds_read_b64_tr_b16 v[254:255], v24 offset:45056
    s_waitcnt lgkmcnt(11)
    v_mfma_f32_16x16x32_bf16 v[168:171], v[240:243], v[84:87], v[168:171]
    ds_read_b128 v[20:23], v16 offset:0
    ds_read_b64_tr_b16 v[228:229], v25 offset:40960
    v_mfma_f32_16x16x32_bf16 v[184:187], v[240:243], v[88:91], v[184:187]
    ds_read_b64_tr_b16 v[230:231], v25 offset:45056
    v_mfma_f32_16x16x32_bf16 v[200:203], v[240:243], v[36:39], v[200:203]
    v_mfma_f32_16x16x32_bf16 v[216:219], v[240:243], v[40:43], v[216:219]
    s_waitcnt lgkmcnt(12)
    v_mfma_f32_16x16x32_bf16 v[172:175], v[244:247], v[84:87], v[172:175]
    ds_read_b64_tr_b16 v[232:233], v26 offset:40960
    ds_read_b64_tr_b16 v[234:235], v26 offset:45056
    v_mfma_f32_16x16x32_bf16 v[188:191], v[244:247], v[88:91], v[188:191]
    v_mfma_f32_16x16x32_bf16 v[204:207], v[244:247], v[36:39], v[204:207]
    v_mfma_f32_16x16x32_bf16 v[220:223], v[244:247], v[40:43], v[220:223]
    s_waitcnt lgkmcnt(12)
    v_mfma_f32_16x16x32_bf16 v[176:179], v[248:251], v[84:87], v[176:179]
    ds_read_b64_tr_b16 v[236:237], v27 offset:40960
    ds_read_b64_tr_b16 v[238:239], v27 offset:45056
    v_mfma_f32_16x16x32_bf16 v[192:195], v[248:251], v[88:91], v[192:195]
    v_mfma_f32_16x16x32_bf16 v[208:211], v[248:251], v[36:39], v[208:211]
    v_mfma_f32_16x16x32_bf16 v[224:227], v[248:251], v[40:43], v[224:227]
    s_waitcnt lgkmcnt(7)
    v_mfma_f32_16x16x32_bf16 v[164:167], v[252:255], v[92:95], v[164:167]
    s_waitcnt lgkmcnt(6)
    v_min_u32 v20, v20, v21
    s_nop 0
    v_readfirstlane_b32 s85, v20
    s_cmp_ge_u32 s85, 8
    s_cbranch_scc0 Las56
Lak57:
    v_mfma_f32_16x16x32_bf16 v[180:183], v[252:255], v[96:99], v[180:183]
    ds_read_b128 v[100:103], v28 offset:49152
    ds_read_b128 v[104:107], v28 offset:51200
    v_mfma_f32_16x16x32_bf16 v[196:199], v[252:255], v[44:47], v[196:199]
    ds_read_b128 v[36:39], v30 offset:49152
    ds_read_b128 v[40:43], v30 offset:51200
    v_mfma_f32_16x16x32_bf16 v[212:215], v[252:255], v[48:51], v[212:215]
    ds_read_b64_tr_b16 v[240:241], v24 offset:49152
    ds_read_b64_tr_b16 v[242:243], v24 offset:53248
    s_waitcnt lgkmcnt(10)
    v_mfma_f32_16x16x32_bf16 v[168:171], v[228:231], v[92:95], v[168:171]
    ds_read_b64_tr_b16 v[244:245], v25 offset:49152
    ds_read_b64_tr_b16 v[246:247], v25 offset:53248
    v_mfma_f32_16x16x32_bf16 v[184:187], v[228:231], v[96:99], v[184:187]
    v_mfma_f32_16x16x32_bf16 v[200:203], v[228:231], v[44:47], v[200:203]
    v_mfma_f32_16x16x32_bf16 v[216:219], v[228:231], v[48:51], v[216:219]
    s_waitcnt lgkmcnt(10)
    v_mfma_f32_16x16x32_bf16 v[172:175], v[232:235], v[92:95], v[172:175]
    ds_read_b64_tr_b16 v[248:249], v26 offset:49152
    ds_read_b64_tr_b16 v[250:251], v26 offset:53248
    v_mfma_f32_16x16x32_bf16 v[188:191], v[232:235], v[96:99], v[188:191]
    v_mfma_f32_16x16x32_bf16 v[204:207], v[232:235], v[44:47], v[204:207]
    v_mfma_f32_16x16x32_bf16 v[220:223], v[232:235], v[48:51], v[220:223]
    s_waitcnt lgkmcnt(10)
    v_mfma_f32_16x16x32_bf16 v[176:179], v[236:239], v[92:95], v[176:179]
    ds_read_b64_tr_b16 v[252:253], v27 offset:49152
    ds_read_b64_tr_b16 v[254:255], v27 offset:53248
    v_mfma_f32_16x16x32_bf16 v[192:195], v[236:239], v[96:99], v[192:195]
    v_mfma_f32_16x16x32_bf16 v[208:211], v[236:239], v[44:47], v[208:211]
    v_mfma_f32_16x16x32_bf16 v[224:227], v[236:239], v[48:51], v[224:227]
    s_waitcnt lgkmcnt(6)
    v_mfma_f32_16x16x32_bf16 v[164:167], v[240:243], v[100:103], v[164:167]
    v_mov_b32 v18, 3
    ds_max_u32 v17, v18 offset:16
    ds_read_b128 v[108:111], v29 offset:49152
    v_mfma_f32_16x16x32_bf16 v[180:183], v[240:243], v[104:107], v[180:183]
    ds_read_b128 v[112:115], v29 offset:51200
    ds_read_b128 v[44:47], v31 offset:49152
    v_mfma_f32_16x16x32_bf16 v[196:199], v[240:243], v[36:39], v[196:199]
    ds_read_b128 v[48:51], v31 offset:51200
    ds_read_b64_tr_b16 v[228:229], v24 offset:57344
    v_mfma_f32_16x16x32_bf16 v[212:215], v[240:243], v[40:43], v[212:215]
    ds_read_b64_tr_b16 v[230:231], v24 offset:61440
    s_waitcnt lgkmcnt(11)
    v_mfma_f32_16x16x32_bf16 v[168:171], v[244:247], v[100:103], v[168:171]
    ds_read_b128 v[20:23], v16 offset:0
    ds_read_b64_tr_b16 v[232:233], v25 offset:57344
    v_mfma_f32_16x16x32_bf16 v[184:187], v[244:247], v[104:107], v[184:187]
    ds_read_b64_tr_b16 v[234:235], v25 offset:61440
    v_mfma_f32_16x16x32_bf16 v[200:203], v[244:247], v[36:39], v[200:203]
    v_mfma_f32_16x16x32_bf16 v[216:219], v[244:247], v[40:43], v[216:219]
    s_waitcnt lgkmcnt(12)
    v_mfma_f32_16x16x32_bf16 v[172:175], v[248:251], v[100:103], v[172:175]
    ds_read_b64_tr_b16 v[236:237], v26 offset:57344
    ds_read_b64_tr_b16 v[238:239], v26 offset:61440
    v_mfma_f32_16x16x32_bf16 v[188:191], v[248:251], v[104:107], v[188:191]
    v_mfma_f32_16x16x32_bf16 v[204:207], v[248:251], v[36:39], v[204:207]
    v_mfma_f32_16x16x32_bf16 v[220:223], v[248:251], v[40:43], v[220:223]
    s_waitcnt lgkmcnt(12)
    v_mfma_f32_16x16x32_bf16 v[176:179], v[252:255], v[100:103], v[176:179]
    ds_read_b64_tr_b16 v[240:241], v27 offset:57344
    ds_read_b64_tr_b16 v[242:243], v27 offset:61440
    v_mfma_f32_16x16x32_bf16 v[192:195], v[252:255], v[104:107], v[192:195]
    v_mfma_f32_16x16x32_bf16 v[208:211], v[252:255], v[36:39], v[208:211]
    v_mfma_f32_16x16x32_bf16 v[224:227], v[252:255], v[40:43], v[224:227]
    s_waitcnt lgkmcnt(7)
    v_mfma_f32_16x16x32_bf16 v[164:167], v[228:231], v[108:111], v[164:167]
    s_waitcnt lgkmcnt(6)
    v_min_u32 v20, v20, v21
    s_nop 0
    v_readfirstlane_b32 s85, v20
    s_cmp_ge_u32 s85, 10
    s_cbranch_scc0 Las58
Lak59:
    v_mfma_f32_16x16x32_bf16 v[180:183], v[228:231], v[112:115], v[180:183]
    ds_read_b128 v[116:119], v28 offset:0
    ds_read_b128 v[120:123], v28 offset:2048
    v_mfma_f32_16x16x32_bf16 v[196:199], v[228:231], v[44:47], v[196:199]
    ds_read_b128 v[36:39], v30 offset:0
    ds_read_b128 v[40:43], v30 offset:2048
    v_mfma_f32_16x16x32_bf16 v[212:215], v[228:231], v[48:51], v[212:215]
    ds_read_b64_tr_b16 v[244:245], v24 offset:0
    ds_read_b64_tr_b16 v[246:247], v24 offset:4096
    s_waitcnt lgkmcnt(10)
    v_mfma_f32_16x16x32_bf16 v[168:171], v[232:235], v[108:111], v[168:171]
    ds_read_b64_tr_b16 v[248:249], v25 offset:0
    ds_read_b64_tr_b16 v[250:251], v25 offset:4096
    v_mfma_f32_16x16x32_bf16 v[184:187], v[232:235], v[112:115], v[184:187]
    v_mfma_f32_16x16x32_bf16 v[200:203], v[232:235], v[44:47], v[200:203]
    v_mfma_f32_16x16x32_bf16 v[216:219], v[232:235], v[48:51], v[216:219]
    s_waitcnt lgkmcnt(10)
    v_mfma_f32_16x16x32_bf16 v[172:175], v[236:239], v[108:111], v[172:175]
    ds_read_b64_tr_b16 v[252:253], v26 offset:0
    ds_read_b64_tr_b16 v[254:255], v26 offset:4096
    v_mfma_f32_16x16x32_bf16 v[188:191], v[236:239], v[112:115], v[188:191]
    v_mfma_f32_16x16x32_bf16 v[204:207], v[236:239], v[44:47], v[204:207]
    v_mfma_f32_16x16x32_bf16 v[220:223], v[236:239], v[48:51], v[220:223]
    s_waitcnt lgkmcnt(10)
    v_mfma_f32_16x16x32_bf16 v[176:179], v[240:243], v[108:111], v[176:179]
    ds_read_b64_tr_b16 v[228:229], v27 offset:0
    ds_read_b64_tr_b16 v[230:231], v27 offset:4096
    v_mfma_f32_16x16x32_bf16 v[192:195], v[240:243], v[112:115], v[192:195]
    v_mfma_f32_16x16x32_bf16 v[208:211], v[240:243], v[44:47], v[208:211]
    v_mfma_f32_16x16x32_bf16 v[224:227], v[240:243], v[48:51], v[224:227]
    s_waitcnt lgkmcnt(6)
    v_mfma_f32_16x16x32_bf16 v[164:167], v[244:247], v[116:119], v[164:167]
    v_mov_b32 v18, 4
    ds_max_u32 v17, v18 offset:16
    ds_read_b128 v[124:127], v29 offset:0
    v_mfma_f32_16x16x32_bf16 v[180:183], v[244:247], v[120:123], v[180:183]
    ds_read_b128 v[128:131], v29 offset:2048
    ds_read_b128 v[44:47], v31 offset:0
    v_mfma_f32_16x16x32_bf16 v[196:199], v[244:247], v[36:39], v[196:199]
    ds_read_b128 v[48:51], v31 offset:2048
    ds_read_b64_tr_b16 v[232:233], v24 offset:8192
    v_mfma_f32_16x16x32_bf16 v[212:215], v[244:247], v[40:43], v[212:215]
    ds_read_b64_tr_b16 v[234:235], v24 offset:12288
    s_waitcnt lgkmcnt(11)
    v_mfma_f32_16x16x32_bf16 v[168:171], v[248:251], v[116:119], v[168:171]
    ds_read_b128 v[20:23], v16 offset:0
    ds_read_b64_tr_b16 v[236:237], v25 offset:8192
    v_mfma_f32_16x16x32_bf16 v[184:187], v[248:251], v[120:123], v[184:187]
    ds_read_b64_tr_b16 v[238:239], v25 offset:12288
    v_mfma_f32_16x16x32_bf16 v[200:203], v[248:251], v[36:39], v[200:203]
    v_mfma_f32_16x16x32_bf16 v[216:219], v[248:251], v[40:43], v[216:219]
    s_waitcnt lgkmcnt(12)
    v_mfma_f32_16x16x32_bf16 v[172:175], v[252:255], v[116:119], v[172:175]
    ds_read_b64_tr_b16 v[240:241], v26 offset:8192
    ds_read_b64_tr_b16 v[242:243], v26 offset:12288
    v_mfma_f32_16x16x32_bf16 v[188:191], v[252:255], v[120:123], v[188:191]
    v_mfma_f32_16x16x32_bf16 v[204:207], v[252:255], v[36:39], v[204:207]
    v_mfma_f32_16x16x32_bf16 v[220:223], v[252:255], v[40:43], v[220:223]
    s_waitcnt lgkmcnt(12)
    v_mfma_f32_16x16x32_bf16 v[176:179], v[228:231], v[116:119], v[176:179]
    ds_read_b64_tr_b16 v[244:245], v27 offset:8192
    ds_read_b64_tr_b16 v[246:247], v27 offset:12288
    v_mfma_f32_16x16x32_bf16 v[192:195], v[228:231], v[120:123], v[192:195]
    v_mfma_f32_16x16x32_bf16 v[208:211], v[228:231], v[36:39], v[208:211]
    v_mfma_f32_16x16x32_bf16 v[224:227], v[228:231], v[40:43], v[224:227]
    s_waitcnt lgkmcnt(7)
    v_mfma_f32_16x16x32_bf16 v[164:167], v[232:235], v[124:127], v[164:167]
    s_waitcnt lgkmcnt(6)
    v_min_u32 v20, v20, v21
    s_nop 0
    v_readfirstlane_b32 s85, v20
    s_cmp_ge_u32 s85, 12
    s_cbranch_scc0 Las60
Lak61:
    v_mfma_f32_16x16x32_bf16 v[180:183], v[232:235], v[128:131], v[180:183]
    ds_read_b128 v[132:135], v28 offset:16384
    ds_read_b128 v[136:139], v28 offset:18432
    v_mfma_f32_16x16x32_bf16 v[196:199], v[232:235], v[44:47], v[196:199]
    ds_read_b128 v[36:39], v30 offset:16384
    ds_read_b128 v[40:43], v30 offset:18432
    v_mfma_f32_16x16x32_bf16 v[212:215], v[232:235], v[48:51], v[212:215]
    ds_read_b64_tr_b16 v[248:249], v24 offset:16384
    ds_read_b64_tr_b16 v[250:251], v24 offset:20480
    s_waitcnt lgkmcnt(10)
    v_mfma_f32_16x16x32_bf16 v[168:171], v[236:239], v[124:127], v[168:171]
    ds_read_b64_tr_b16 v[252:253], v25 offset:16384
    ds_read_b64_tr_b16 v[254:255], v25 offset:20480
    v_mfma_f32_16x16x32_bf16 v[184:187], v[236:239], v[128:131], v[184:187]
    v_mfma_f32_16x16x32_bf16 v[200:203], v[236:239], v[44:47], v[200:203]
    v_mfma_f32_16x16x32_bf16 v[216:219], v[236:239], v[48:51], v[216:219]
    s_waitcnt lgkmcnt(10)
    v_mfma_f32_16x16x32_bf16 v[172:175], v[240:243], v[124:127], v[172:175]
    ds_read_b64_tr_b16 v[228:229], v26 offset:16384
    ds_read_b64_tr_b16 v[230:231], v26 offset:20480
    v_mfma_f32_16x16x32_bf16 v[188:191], v[240:243], v[128:131], v[188:191]
    v_mfma_f32_16x16x32_bf16 v[204:207], v[240:243], v[44:47], v[204:207]
    v_mfma_f32_16x16x32_bf16 v[220:223], v[240:243], v[48:51], v[220:223]
    s_waitcnt lgkmcnt(10)
    v_mfma_f32_16x16x32_bf16 v[176:179], v[244:247], v[124:127], v[176:179]
    ds_read_b64_tr_b16 v[232:233], v27 offset:16384
    ds_read_b64_tr_b16 v[234:235], v27 offset:20480
    v_mfma_f32_16x16x32_bf16 v[192:195], v[244:247], v[128:131], v[192:195]
    v_mfma_f32_16x16x32_bf16 v[208:211], v[244:247], v[44:47], v[208:211]
    v_mfma_f32_16x16x32_bf16 v[224:227], v[244:247], v[48:51], v[224:227]
    s_waitcnt lgkmcnt(6)
    v_mfma_f32_16x16x32_bf16 v[164:167], v[248:251], v[132:135], v[164:167]
    v_mov_b32 v18, 5
    ds_max_u32 v17, v18 offset:16
    ds_read_b128 v[140:143], v29 offset:16384
    v_mfma_f32_16x16x32_bf16 v[180:183], v[248:251], v[136:139], v[180:183]
    ds_read_b128 v[144:147], v29 offset:18432
    ds_read_b128 v[44:47], v31 offset:16384
    v_mfma_f32_16x16x32_bf16 v[196:199], v[248:251], v[36:39], v[196:199]
    ds_read_b128 v[48:51], v31 offset:18432
    ds_read_b64_tr_b16 v[236:237], v24 offset:24576
    v_mfma_f32_16x16x32_bf16 v[212:215], v[248:251], v[40:43], v[212:215]
    ds_read_b64_tr_b16 v[238:239], v24 offset:28672
    s_waitcnt lgkmcnt(11)
    v_mfma_f32_16x16x32_bf16 v[168:171], v[252:255], v[132:135], v[168:171]
    ds_read_b128 v[20:23], v16 offset:0
    ds_read_b64_tr_b16 v[240:241], v25 offset:24576
    v_mfma_f32_16x16x32_bf16 v[184:187], v[252:255], v[136:139], v[184:187]
    ds_read_b64_tr_b16 v[242:243], v25 offset:28672
    v_mfma_f32_16x16x32_bf16 v[200:203], v[252:255], v[36:39], v[200:203]
    v_mfma_f32_16x16x32_bf16 v[216:219], v[252:255], v[40:43], v[216:219]
    s_waitcnt lgkmcnt(12)
    v_mfma_f32_16x16x32_bf16 v[172:175], v[228:231], v[132:135], v[172:175]
    ds_read_b64_tr_b16 v[244:245], v26 offset:24576
    ds_read_b64_tr_b16 v[246:247], v26 offset:28672
    v_mfma_f32_16x16x32_bf16 v[188:191], v[228:231], v[136:139], v[188:191]
    v_mfma_f32_16x16x32_bf16 v[204:207], v[228:231], v[36:39], v[204:207]
    v_mfma_f32_16x16x32_bf16 v[220:223], v[228:231], v[40:43], v[220:223]
    s_waitcnt lgkmcnt(12)
    v_mfma_f32_16x16x32_bf16 v[176:179], v[232:235], v[132:135], v[176:179]
    ds_read_b64_tr_b16 v[248:249], v27 offset:24576
    ds_read_b64_tr_b16 v[250:251], v27 offset:28672
    v_mfma_f32_16x16x32_bf16 v[192:195], v[232:235], v[136:139], v[192:195]
    v_mfma_f32_16x16x32_bf16 v[208:211], v[232:235], v[36:39], v[208:211]
    v_mfma_f32_16x16x32_bf16 v[224:227], v[232:235], v[40:43], v[224:227]
    s_waitcnt lgkmcnt(7)
    v_mfma_f32_16x16x32_bf16 v[164:167], v[236:239], v[140:143], v[164:167]
    s_waitcnt lgkmcnt(6)
    v_min_u32 v20, v20, v21
    s_nop 0
    v_readfirstlane_b32 s85, v20
    s_cmp_ge_u32 s85, 14
    s_cbranch_scc0 Las62
Lak63:
    v_mfma_f32_16x16x32_bf16 v[180:183], v[236:239], v[144:147], v[180:183]
    ds_read_b128 v[148:151], v28 offset:32768
    ds_read_b128 v[152:155], v28 offset:34816
    v_mfma_f32_16x16x32_bf16 v[196:199], v[236:239], v[44:47], v[196:199]
    ds_read_b128 v[36:39], v30 offset:32768
    ds_read_b128 v[40:43], v30 offset:34816
    v_mfma_f32_16x16x32_bf16 v[212:215], v[236:239], v[48:51], v[212:215]
    ds_read_b64_tr_b16 v[252:253], v24 offset:32768
    ds_read_b64_tr_b16 v[254:255], v24 offset:36864
    s_waitcnt lgkmcnt(10)
    v_mfma_f32_16x16x32_bf16 v[168:171], v[240:243], v[140:143], v[168:171]
    ds_read_b64_tr_b16 v[228:229], v25 offset:32768
    ds_read_b64_tr_b16 v[230:231], v25 offset:36864
    v_mfma_f32_16x16x32_bf16 v[184:187], v[240:243], v[144:147], v[184:187]
    v_mfma_f32_16x16x32_bf16 v[200:203], v[240:243], v[44:47], v[200:203]
    v_mfma_f32_16x16x32_bf16 v[216:219], v[240:243], v[48:51], v[216:219]
    s_waitcnt lgkmcnt(10)
    v_mfma_f32_16x16x32_bf16 v[172:175], v[244:247], v[140:143], v[172:175]
    ds_read_b64_tr_b16 v[232:233], v26 offset:32768
    ds_read_b64_tr_b16 v[234:235], v26 offset:36864
    v_mfma_f32_16x16x32_bf16 v[188:191], v[244:247], v[144:147], v[188:191]
    v_mfma_f32_16x16x32_bf16 v[204:207], v[244:247], v[44:47], v[204:207]
    v_mfma_f32_16x16x32_bf16 v[220:223], v[244:247], v[48:51], v[220:223]
    s_waitcnt lgkmcnt(10)
    v_mfma_f32_16x16x32_bf16 v[176:179], v[248:251], v[140:143], v[176:179]
    ds_read_b64_tr_b16 v[236:237], v27 offset:32768
    ds_read_b64_tr_b16 v[238:239], v27 offset:36864
    v_mfma_f32_16x16x32_bf16 v[192:195], v[248:251], v[144:147], v[192:195]
    v_mfma_f32_16x16x32_bf16 v[208:211], v[248:251], v[44:47], v[208:211]
    v_mfma_f32_16x16x32_bf16 v[224:227], v[248:251], v[48:51], v[224:227]
    s_waitcnt lgkmcnt(6)
    v_mfma_f32_16x16x32_bf16 v[164:167], v[252:255], v[148:151], v[164:167]
    v_mov_b32 v18, 6
    ds_max_u32 v17, v18 offset:16
    ds_read_b128 v[156:159], v29 offset:32768
    v_mfma_f32_16x16x32_bf16 v[180:183], v[252:255], v[152:155], v[180:183]
    ds_read_b128 v[160:163], v29 offset:34816
    ds_read_b128 v[44:47], v31 offset:32768
    v_mfma_f32_16x16x32_bf16 v[196:199], v[252:255], v[36:39], v[196:199]
    ds_read_b128 v[48:51], v31 offset:34816
    ds_read_b64_tr_b16 v[240:241], v24 offset:40960
    v_mfma_f32_16x16x32_bf16 v[212:215], v[252:255], v[40:43], v[212:215]
    ds_read_b64_tr_b16 v[242:243], v24 offset:45056
    s_waitcnt lgkmcnt(11)
    v_mfma_f32_16x16x32_bf16 v[168:171], v[228:231], v[148:151], v[168:171]
    ds_read_b64_tr_b16 v[244:245], v25 offset:40960
    ds_read_b64_tr_b16 v[246:247], v25 offset:45056
    v_mfma_f32_16x16x32_bf16 v[184:187], v[228:231], v[152:155], v[184:187]
    v_mfma_f32_16x16x32_bf16 v[200:203], v[228:231], v[36:39], v[200:203]
    v_mfma_f32_16x16x32_bf16 v[216:219], v[228:231], v[40:43], v[216:219]
    s_waitcnt lgkmcnt(11)
    v_mfma_f32_16x16x32_bf16 v[172:175], v[232:235], v[148:151], v[172:175]
    ds_read_b64_tr_b16 v[248:249], v26 offset:40960
    ds_read_b64_tr_b16 v[250:251], v26 offset:45056
    v_mfma_f32_16x16x32_bf16 v[188:191], v[232:235], v[152:155], v[188:191]
    v_mfma_f32_16x16x32_bf16 v[204:207], v[232:235], v[36:39], v[204:207]
    v_mfma_f32_16x16x32_bf16 v[220:223], v[232:235], v[40:43], v[220:223]
    s_waitcnt lgkmcnt(11)
    v_mfma_f32_16x16x32_bf16 v[176:179], v[236:239], v[148:151], v[176:179]
    ds_read_b64_tr_b16 v[252:253], v27 offset:40960
    ds_read_b64_tr_b16 v[254:255], v27 offset:45056
    v_mfma_f32_16x16x32_bf16 v[192:195], v[236:239], v[152:155], v[192:195]
    v_mfma_f32_16x16x32_bf16 v[208:211], v[236:239], v[36:39], v[208:211]
    v_mfma_f32_16x16x32_bf16 v[224:227], v[236:239], v[40:43], v[224:227]
    s_waitcnt lgkmcnt(6)
    v_mfma_f32_16x16x32_bf16 v[164:167], v[240:243], v[156:159], v[164:167]
    v_mfma_f32_16x16x32_bf16 v[180:183], v[240:243], v[160:163], v[180:183]
    v_mfma_f32_16x16x32_bf16 v[196:199], v[240:243], v[44:47], v[196:199]
    v_mfma_f32_16x16x32_bf16 v[212:215], v[240:243], v[48:51], v[212:215]
    s_waitcnt lgkmcnt(4)
    v_mfma_f32_16x16x32_bf16 v[168:171], v[244:247], v[156:159], v[168:171]
    v_mfma_f32_16x16x32_bf16 v[184:187], v[244:247], v[160:163], v[184:187]
    v_mfma_f32_16x16x32_bf16 v[200:203], v[244:247], v[44:47], v[200:203]
    v_mfma_f32_16x16x32_bf16 v[216:219], v[244:247], v[48:51], v[216:219]
    s_waitcnt lgkmcnt(2)
    v_mfma_f32_16x16x32_bf16 v[172:175], v[248:251], v[156:159], v[172:175]
    v_mfma_f32_16x16x32_bf16 v[188:191], v[248:251], v[160:163], v[188:191]
    v_mfma_f32_16x16x32_bf16 v[204:207], v[248:251], v[44:47], v[204:207]
    v_mfma_f32_16x16x32_bf16 v[220:223], v[248:251], v[48:51], v[220:223]
    s_waitcnt lgkmcnt(0)
    v_mfma_f32_16x16x32_bf16 v[176:179], v[252:255], v[156:159], v[176:179]
    v_mfma_f32_16x16x32_bf16 v[192:195], v[252:255], v[160:163], v[192:195]
    v_mfma_f32_16x16x32_bf16 v[208:211], v[252:255], v[44:47], v[208:211]
    v_mfma_f32_16x16x32_bf16 v[224:227], v[252:255], v[48:51], v[224:227]
    v_max_f32 v164, 0, v164
    v_max_f32 v165, 0, v165
    v_max_f32 v166, 0, v166
    v_max_f32 v167, 0, v167
    v_pk_mul_f32 v[164:165], v[164:165], v[164:165]
    v_pk_mul_f32 v[166:167], v[166:167], v[166:167]
    v_cvt_pk_bf16_f32 v164, v164, v165
    v_cvt_pk_bf16_f32 v165, v166, v167
    v_max_f32 v168, 0, v168
    v_max_f32 v169, 0, v169
    v_max_f32 v170, 0, v170
    v_max_f32 v171, 0, v171
    v_pk_mul_f32 v[168:169], v[168:169], v[168:169]
    v_pk_mul_f32 v[170:171], v[170:171], v[170:171]
    v_cvt_pk_bf16_f32 v166, v168, v169
    v_cvt_pk_bf16_f32 v167, v170, v171
    buffer_store_dwordx4 v[164:167], v32, s[20:23], s54 offen offset:0 sc1
    v_max_f32 v180, 0, v180
    v_max_f32 v181, 0, v181
    v_max_f32 v182, 0, v182
    v_max_f32 v183, 0, v183
    v_pk_mul_f32 v[180:181], v[180:181], v[180:181]
    v_pk_mul_f32 v[182:183], v[182:183], v[182:183]
    v_cvt_pk_bf16_f32 v180, v180, v181
    v_cvt_pk_bf16_f32 v181, v182, v183
    v_max_f32 v184, 0, v184
    v_max_f32 v185, 0, v185
    v_max_f32 v186, 0, v186
    v_max_f32 v187, 0, v187
    v_pk_mul_f32 v[184:185], v[184:185], v[184:185]
    v_pk_mul_f32 v[186:187], v[186:187], v[186:187]
    v_cvt_pk_bf16_f32 v182, v184, v185
    v_cvt_pk_bf16_f32 v183, v186, v187
    buffer_store_dwordx4 v[180:183], v32, s[20:23], s55 offen offset:0 sc1
    v_max_f32 v196, 0, v196
    v_max_f32 v197, 0, v197
    v_max_f32 v198, 0, v198
    v_max_f32 v199, 0, v199
    v_pk_mul_f32 v[196:197], v[196:197], v[196:197]
    v_pk_mul_f32 v[198:199], v[198:199], v[198:199]
    v_cvt_pk_bf16_f32 v196, v196, v197
    v_cvt_pk_bf16_f32 v197, v198, v199
    v_max_f32 v200, 0, v200
    v_max_f32 v201, 0, v201
    v_max_f32 v202, 0, v202
    v_max_f32 v203, 0, v203
    v_pk_mul_f32 v[200:201], v[200:201], v[200:201]
    v_pk_mul_f32 v[202:203], v[202:203], v[202:203]
    v_cvt_pk_bf16_f32 v198, v200, v201
    v_cvt_pk_bf16_f32 v199, v202, v203
    buffer_store_dwordx4 v[196:199], v32, s[20:23], s56 offen offset:0 sc1
    v_max_f32 v212, 0, v212
    v_max_f32 v213, 0, v213
    v_max_f32 v214, 0, v214
    v_max_f32 v215, 0, v215
    v_pk_mul_f32 v[212:213], v[212:213], v[212:213]
    v_pk_mul_f32 v[214:215], v[214:215], v[214:215]
    v_cvt_pk_bf16_f32 v212, v212, v213
    v_cvt_pk_bf16_f32 v213, v214, v215
    v_max_f32 v216, 0, v216
    v_max_f32 v217, 0, v217
    v_max_f32 v218, 0, v218
    v_max_f32 v219, 0, v219
    v_pk_mul_f32 v[216:217], v[216:217], v[216:217]
    v_pk_mul_f32 v[218:219], v[218:219], v[218:219]
    v_cvt_pk_bf16_f32 v214, v216, v217
    v_cvt_pk_bf16_f32 v215, v218, v219
    buffer_store_dwordx4 v[212:215], v32, s[20:23], s57 offen offset:0 sc1
    v_max_f32 v172, 0, v172
    v_max_f32 v173, 0, v173
    v_max_f32 v174, 0, v174
    v_max_f32 v175, 0, v175
    v_pk_mul_f32 v[172:173], v[172:173], v[172:173]
    v_pk_mul_f32 v[174:175], v[174:175], v[174:175]
    v_cvt_pk_bf16_f32 v172, v172, v173
    v_cvt_pk_bf16_f32 v173, v174, v175
    v_max_f32 v176, 0, v176
    v_max_f32 v177, 0, v177
    v_max_f32 v178, 0, v178
    v_max_f32 v179, 0, v179
    v_pk_mul_f32 v[176:177], v[176:177], v[176:177]
    v_pk_mul_f32 v[178:179], v[178:179], v[178:179]
    v_cvt_pk_bf16_f32 v174, v176, v177
    v_cvt_pk_bf16_f32 v175, v178, v179
    buffer_store_dwordx4 v[172:175], v33, s[20:23], s54 offen offset:1024 sc1
    v_max_f32 v188, 0, v188
    v_max_f32 v189, 0, v189
    v_max_f32 v190, 0, v190
    v_max_f32 v191, 0, v191
    v_pk_mul_f32 v[188:189], v[188:189], v[188:189]
    v_pk_mul_f32 v[190:191], v[190:191], v[190:191]
    v_cvt_pk_bf16_f32 v188, v188, v189
    v_cvt_pk_bf16_f32 v189, v190, v191
    v_max_f32 v192, 0, v192
    v_max_f32 v193, 0, v193
    v_max_f32 v194, 0, v194
    v_max_f32 v195, 0, v195
    v_pk_mul_f32 v[192:193], v[192:193], v[192:193]
    v_pk_mul_f32 v[194:195], v[194:195], v[194:195]
    v_cvt_pk_bf16_f32 v190, v192, v193
    v_cvt_pk_bf16_f32 v191, v194, v195
    buffer_store_dwordx4 v[188:191], v33, s[20:23], s55 offen offset:1024 sc1
    v_max_f32 v204, 0, v204
    v_max_f32 v205, 0, v205
    v_max_f32 v206, 0, v206
    v_max_f32 v207, 0, v207
    v_pk_mul_f32 v[204:205], v[204:205], v[204:205]
    v_pk_mul_f32 v[206:207], v[206:207], v[206:207]
    v_cvt_pk_bf16_f32 v204, v204, v205
    v_cvt_pk_bf16_f32 v205, v206, v207
    v_max_f32 v208, 0, v208
    v_max_f32 v209, 0, v209
    v_max_f32 v210, 0, v210
    v_max_f32 v211, 0, v211
    v_pk_mul_f32 v[208:209], v[208:209], v[208:209]
    v_pk_mul_f32 v[210:211], v[210:211], v[210:211]
    v_cvt_pk_bf16_f32 v206, v208, v209
    v_cvt_pk_bf16_f32 v207, v210, v211
    buffer_store_dwordx4 v[204:207], v33, s[20:23], s56 offen offset:1024 sc1
    v_max_f32 v220, 0, v220
    v_max_f32 v221, 0, v221
    v_max_f32 v222, 0, v222
    v_max_f32 v223, 0, v223
    v_pk_mul_f32 v[220:221], v[220:221], v[220:221]
    v_pk_mul_f32 v[222:223], v[222:223], v[222:223]
    v_cvt_pk_bf16_f32 v220, v220, v221
    v_cvt_pk_bf16_f32 v221, v222, v223
    v_max_f32 v224, 0, v224
    v_max_f32 v225, 0, v225
    v_max_f32 v226, 0, v226
    v_max_f32 v227, 0, v227
    v_pk_mul_f32 v[224:225], v[224:225], v[224:225]
    v_pk_mul_f32 v[226:227], v[226:227], v[226:227]
    v_cvt_pk_bf16_f32 v222, v224, v225
    v_cvt_pk_bf16_f32 v223, v226, v227
    buffer_store_dwordx4 v[220:223], v33, s[20:23], s57 offen offset:1024 sc1
    v_mov_b32 v18, 7
    ds_max_u32 v17, v18 offset:16
    v_bfe_u32 v14, v1, 4, 1
    v_lshlrev_b32 v36, 6, v13
    v_lshl_add_u32 v36, v14, 5, v36
    v_lshl_add_u32 v36, v12, 3, v36
    v_xor_b32 v37, 32, v36
    s_and_b32 s84, s86, 1
    s_lshl_b32 s84, s84, 5
    s_lshr_b32 s85, s86, 1
    s_lshl_b32 s85, s85, 12
    v_xor_b32 v38, s84, v36
    v_add_u32 v38, s85, v38
    v_and_b32 v45, 0x7ff, v28
    v_xor_b32 v46, 64, v45
    v_add_u32 v39, 65536, v36
    v_add_u32 v40, 65536, v37
    v_add_u32 v41, 65536, v38
    v_add_u32 v47, 65536, v45
    v_add_u32 v48, 65536, v46
    v_add_u32 v42, 131072, v36
    v_add_u32 v43, 131072, v37
    v_add_u32 v44, 131072, v38
    v_add_u32 v49, 131072, v45
    v_add_u32 v50, 131072, v46
Lnc64:
    ds_read_b64 v[6:7], v16 offset:64
    s_waitcnt lgkmcnt(0)
    v_readfirstlane_b32 s82, v6
    v_readfirstlane_b32 s83, v7
    s_cmp_lg_u32 s82, 0
    s_cbranch_scc1 Lnk65
    s_sleep 2
    s_add_u32 s92, s92, 1
    s_cmp_lt_u32 s92, 0x200000
    s_cbranch_scc1 Lnc64
Lnk65:
    s_mov_b32 s53, 0
    s_getreg_b32 s84, hwreg(HW_REG_IB_STS)
    s_and_b32 s84, s84, 0xc0000f
    s_or_b32 s84, s84, s53
    s_cbranch_scc0 Lap66
Lab67:
    ds_read_b128 v[20:23], v16 offset:0
    s_waitcnt lgkmcnt(0)
Llw80:
    v_min3_u32 v20, v20, v21, v22
    v_min_u32 v20, v20, v23
    s_nop 0
    v_readfirstlane_b32 s85, v20
    s_cmp_ge_u32 s85, 15
    s_cbranch_scc1 Llk81
    s_sleep 1
    ds_read_b128 v[20:23], v16 offset:0
    s_waitcnt lgkmcnt(0)
    s_add_u32 s92, s92, 1
    s_cmp_lt_u32 s92, 0x200000
    s_cbranch_scc1 Llw80
Llk81:
    ds_read_b64_tr_b16 v[228:229], v42 offset:0
    ds_read_b64_tr_b16 v[230:231], v42 offset:1024
    s_waitcnt lgkmcnt(0)
    v_mfma_f32_16x16x32_bf16 v[164:167], v[228:231], v[52:55], 0
    ds_read_b64_tr_b16 v[232:233], v43 offset:0
    ds_read_b64_tr_b16 v[234:235], v43 offset:1024
    v_mfma_f32_16x16x32_bf16 v[188:191], v[228:231], v[56:59], 0
    ds_read_b64_tr_b16 v[236:237], v42 offset:4096
    ds_read_b64_tr_b16 v[238:239], v42 offset:5120
    s_waitcnt lgkmcnt(2)
    v_mfma_f32_16x16x32_bf16 v[168:171], v[232:235], v[52:55], 0
    ds_read_b64_tr_b16 v[240:241], v43 offset:4096
    ds_read_b64_tr_b16 v[242:243], v43 offset:5120
    v_mfma_f32_16x16x32_bf16 v[192:195], v[232:235], v[56:59], 0
    ds_read_b64_tr_b16 v[244:245], v42 offset:8192
    ds_read_b64_tr_b16 v[246:247], v42 offset:9216
    s_waitcnt lgkmcnt(4)
    v_mfma_f32_16x16x32_bf16 v[172:175], v[236:239], v[52:55], 0
    ds_read_b64_tr_b16 v[248:249], v43 offset:8192
    ds_read_b64_tr_b16 v[250:251], v43 offset:9216
    v_mfma_f32_16x16x32_bf16 v[196:199], v[236:239], v[56:59], 0
    ds_read_b128 v[252:255], v49 offset:12288
    ds_read_b64_tr_b16 v[228:229], v44 offset:4096
    s_waitcnt lgkmcnt(6)
    v_mfma_f32_16x16x32_bf16 v[176:179], v[240:243], v[52:55], 0
    ds_read_b64_tr_b16 v[230:231], v44 offset:5120
    ds_read_b128 v[232:235], v34 offset:0
    v_mfma_f32_16x16x32_bf16 v[200:203], v[240:243], v[56:59], 0
    s_waitcnt lgkmcnt(6)
    v_mfma_f32_16x16x32_bf16 v[180:183], v[52:55], v[244:247], 0
    ds_read_b64_tr_b16 v[236:237], v42 offset:2048
    ds_read_b64_tr_b16 v[238:239], v42 offset:3072
    v_mfma_f32_16x16x32_bf16 v[204:207], v[56:59], v[244:247], 0
    s_waitcnt lgkmcnt(6)
    v_mfma_f32_16x16x32_bf16 v[184:187], v[52:55], v[248:251], 0
    ds_read_b64_tr_b16 v[240:241], v43 offset:2048
    ds_read_b64_tr_b16 v[242:243], v43 offset:3072
    v_mfma_f32_16x16x32_bf16 v[208:211], v[56:59], v[248:251], 0
    s_getreg_b32 s84, hwreg(HW_REG_IB_STS)
    s_and_b32 s84, s84, 0xc0000f
    s_or_b32 s84, s84, s53
    s_cbranch_scc0 Lap82
Lab83:
    s_waitcnt lgkmcnt(5)
    v_mfma_f32_16x16x32_bf16 v[212:215], v[228:231], v[252:255], 0
    ds_read_b64_tr_b16 v[244:245], v42 offset:6144
    ds_read_b64_tr_b16 v[246:247], v42 offset:7168
    s_waitcnt lgkmcnt(6)
    v_mfma_f32_16x16x32_bf16 v[216:219], v[232:235], v[52:55], 0
    ds_read_b64_tr_b16 v[248:249], v43 offset:6144
    ds_read_b64_tr_b16 v[250:251], v43 offset:7168
    v_mfma_f32_16x16x32_bf16 v[220:223], v[232:235], v[56:59], 0
    ds_read_b64_tr_b16 v[252:253], v42 offset:10240
    ds_read_b64_tr_b16 v[254:255], v42 offset:11264
    s_waitcnt lgkmcnt(8)
    v_mfma_f32_16x16x32_bf16 v[164:167], v[236:239], v[60:63], v[164:167]
    ds_read_b64_tr_b16 v[228:229], v43 offset:10240
    ds_read_b64_tr_b16 v[230:231], v43 offset:11264
    v_mfma_f32_16x16x32_bf16 v[188:191], v[236:239], v[64:67], v[188:191]
    s_waitcnt lgkmcnt(8)
    v_mfma_f32_16x16x32_bf16 v[168:171], v[240:243], v[60:63], v[168:171]
    ds_read_b128 v[20:23], v16 offset:0
    ds_read_b128 v[232:235], v50 offset:12288
    v_mfma_f32_16x16x32_bf16 v[192:195], v[240:243], v[64:67], v[192:195]
    s_waitcnt lgkmcnt(8)
    v_mfma_f32_16x16x32_bf16 v[172:175], v[244:247], v[60:63], v[172:175]
    ds_read_b64_tr_b16 v[236:237], v44 offset:6144
    ds_read_b64_tr_b16 v[238:239], v44 offset:7168
    v_mfma_f32_16x16x32_bf16 v[196:199], v[244:247], v[64:67], v[196:199]
    s_waitcnt lgkmcnt(8)
    v_mfma_f32_16x16x32_bf16 v[176:179], v[248:251], v[60:63], v[176:179]
    ds_read_b128 v[240:243], v34 offset:64
    v_mfma_f32_16x16x32_bf16 v[200:203], v[248:251], v[64:67], v[200:203]
    s_getreg_b32 s84, hwreg(HW_REG_IB_STS)
    s_and_b32 s84, s84, 0xc0000f
    s_or_b32 s84, s84, s53
    s_cbranch_scc0 Lap84
Lab85:
    s_waitcnt lgkmcnt(7)
    v_mfma_f32_16x16x32_bf16 v[180:183], v[60:63], v[252:255], v[180:183]
    s_waitcnt lgkmcnt(4)
    v_min_u32 v20, v20, v21
    s_nop 0
    v_readfirstlane_b32 s85, v20
    s_cmp_ge_u32 s85, 16
    s_cbranch_scc0 Las68
Lak69:
    v_mfma_f32_16x16x32_bf16 v[204:207], v[64:67], v[252:255], v[204:207]
    ds_read_b64_tr_b16 v[244:245], v36 offset:0
    ds_read_b64_tr_b16 v[246:247], v36 offset:1024
    v_mfma_f32_16x16x32_bf16 v[184:187], v[60:63], v[228:231], v[184:187]
    ds_read_b64_tr_b16 v[248:249], v37 offset:0
    ds_read_b64_tr_b16 v[250:251], v37 offset:1024
    v_mfma_f32_16x16x32_bf16 v[208:211], v[64:67], v[228:231], v[208:211]
    s_waitcnt lgkmcnt(5)
    v_mfma_f32_16x16x32_bf16 v[212:215], v[236:239], v[232:235], v[212:215]
    ds_read_b64_tr_b16 v[252:253], v36 offset:4096
    ds_read_b64_tr_b16 v[254:255], v36 offset:5120
    s_waitcnt lgkmcnt(6)
    v_mfma_f32_16x16x32_bf16 v[216:219], v[240:243], v[60:63], v[216:219]
    ds_read_b64_tr_b16 v[228:229], v37 offset:4096
    ds_read_b64_tr_b16 v[230:231], v37 offset:5120
    v_mfma_f32_16x16x32_bf16 v[220:223], v[240:243], v[64:67], v[220:223]
    ds_read_b64_tr_b16 v[232:233], v36 offset:8192
    ds_read_b64_tr_b16 v[234:235], v36 offset:9216
    s_waitcnt lgkmcnt(8)
    v_mfma_f32_16x16x32_bf16 v[164:167], v[244:247], v[68:71], v[164:167]
    v_mov_b32 v18, 8
    ds_max_u32 v17, v18 offset:16
    ds_read_b64_tr_b16 v[236:237], v37 offset:8192
    v_mfma_f32_16x16x32_bf16 v[188:191], v[244:247], v[72:75], v[188:191]
    ds_read_b64_tr_b16 v[238:239], v37 offset:9216
    s_getreg_b32 s84, hwreg(HW_REG_IB_STS)
    s_and_b32 s84, s84, 0xc0000f
    s_or_b32 s84, s84, s53
    s_cbranch_scc0 Lap86
Lab87:
    s_waitcnt lgkmcnt(9)
    v_mfma_f32_16x16x32_bf16 v[168:171], v[248:251], v[68:71], v[168:171]
    ds_read_b128 v[240:243], v45 offset:12288
    v_mfma_f32_16x16x32_bf16 v[192:195], v[248:251], v[72:75], v[192:195]
    s_waitcnt lgkmcnt(8)
    v_mfma_f32_16x16x32_bf16 v[172:175], v[252:255], v[68:71], v[172:175]
    ds_read_b64_tr_b16 v[244:245], v38 offset:4096
    ds_read_b64_tr_b16 v[246:247], v38 offset:5120
    v_mfma_f32_16x16x32_bf16 v[196:199], v[252:255], v[72:75], v[196:199]
    s_waitcnt lgkmcnt(8)
    v_mfma_f32_16x16x32_bf16 v[176:179], v[228:231], v[68:71], v[176:179]
    ds_read_b128 v[248:251], v34 offset:128
    v_mfma_f32_16x16x32_bf16 v[200:203], v[228:231], v[72:75], v[200:203]
    s_waitcnt lgkmcnt(7)
    v_mfma_f32_16x16x32_bf16 v[180:183], v[68:71], v[232:235], v[180:183]
    ds_read_b64_tr_b16 v[252:253], v36 offset:2048
    ds_read_b64_tr_b16 v[254:255], v36 offset:3072
    v_mfma_f32_16x16x32_bf16 v[204:207], v[72:75], v[232:235], v[204:207]
    s_waitcnt lgkmcnt(6)
    v_mfma_f32_16x16x32_bf16 v[184:187], v[68:71], v[236:239], v[184:187]
    ds_read_b64_tr_b16 v[228:229], v37 offset:2048
    ds_read_b64_tr_b16 v[230:231], v37 offset:3072
    v_mfma_f32_16x16x32_bf16 v[208:211], v[72:75], v[236:239], v[208:211]
    s_getreg_b32 s84, hwreg(HW_REG_IB_STS)
    s_and_b32 s84, s84, 0xc0000f
    s_or_b32 s84, s84, s53
    s_cbranch_scc0 Lap88
Lab89:
    s_waitcnt lgkmcnt(5)
    v_mfma_f32_16x16x32_bf16 v[212:215], v[244:247], v[240:243], v[212:215]
    ds_read_b64_tr_b16 v[232:233], v36 offset:6144
    ds_read_b64_tr_b16 v[234:235], v36 offset:7168
    s_waitcnt lgkmcnt(6)
    v_mfma_f32_16x16x32_bf16 v[216:219], v[248:251], v[68:71], v[216:219]
    ds_read_b64_tr_b16 v[236:237], v37 offset:6144
    ds_read_b64_tr_b16 v[238:239], v37 offset:7168
    v_mfma_f32_16x16x32_bf16 v[220:223], v[248:251], v[72:75], v[220:223]
    ds_read_b64_tr_b16 v[240:241], v36 offset:10240
    ds_read_b64_tr_b16 v[242:243], v36 offset:11264
    s_waitcnt lgkmcnt(8)
    v_mfma_f32_16x16x32_bf16 v[164:167], v[252:255], v[76:79], v[164:167]
    ds_read_b64_tr_b16 v[244:245], v37 offset:10240
    ds_read_b64_tr_b16 v[246:247], v37 offset:11264
    v_mfma_f32_16x16x32_bf16 v[188:191], v[252:255], v[80:83], v[188:191]
    s_waitcnt lgkmcnt(8)
    v_mfma_f32_16x16x32_bf16 v[168:171], v[228:231], v[76:79], v[168:171]
    ds_read_b128 v[20:23], v16 offset:0
    ds_read_b128 v[248:251], v46 offset:12288
    v_mfma_f32_16x16x32_bf16 v[192:195], v[228:231], v[80:83], v[192:195]
    s_waitcnt lgkmcnt(8)
    v_mfma_f32_16x16x32_bf16 v[172:175], v[232:235], v[76:79], v[172:175]
    ds_read_b64_tr_b16 v[252:253], v38 offset:6144
    ds_read_b64_tr_b16 v[254:255], v38 offset:7168
    v_mfma_f32_16x16x32_bf16 v[196:199], v[232:235], v[80:83], v[196:199]
    s_waitcnt lgkmcnt(8)
    v_mfma_f32_16x16x32_bf16 v[176:179], v[236:239], v[76:79], v[176:179]
    ds_read_b128 v[228:231], v34 offset:192
    v_mfma_f32_16x16x32_bf16 v[200:203], v[236:239], v[80:83], v[200:203]
    s_getreg_b32 s84, hwreg(HW_REG_IB_STS)
    s_and_b32 s84, s84, 0xc0000f
    s_or_b32 s84, s84, s53
    s_cbranch_scc0 Lap90
Lab91:
    s_waitcnt lgkmcnt(7)
    v_mfma_f32_16x16x32_bf16 v[180:183], v[76:79], v[240:243], v[180:183]
    s_waitcnt lgkmcnt(4)
    v_min_u32 v20, v20, v21
    s_nop 0
    v_readfirstlane_b32 s85, v20
    s_cmp_ge_u32 s85, 17
    s_cbranch_scc0 Las70
Lak71:
    v_mfma_f32_16x16x32_bf16 v[204:207], v[80:83], v[240:243], v[204:207]
    ds_read_b64_tr_b16 v[232:233], v39 offset:0
    ds_read_b64_tr_b16 v[234:235], v39 offset:1024
    v_mfma_f32_16x16x32_bf16 v[184:187], v[76:79], v[244:247], v[184:187]
    ds_read_b64_tr_b16 v[236:237], v40 offset:0
    ds_read_b64_tr_b16 v[238:239], v40 offset:1024
    v_mfma_f32_16x16x32_bf16 v[208:211], v[80:83], v[244:247], v[208:211]
    s_waitcnt lgkmcnt(5)
    v_mfma_f32_16x16x32_bf16 v[212:215], v[252:255], v[248:251], v[212:215]
    ds_read_b64_tr_b16 v[240:241], v39 offset:4096
    ds_read_b64_tr_b16 v[242:243], v39 offset:5120
    s_waitcnt lgkmcnt(6)
    v_mfma_f32_16x16x32_bf16 v[216:219], v[228:231], v[76:79], v[216:219]
    ds_read_b64_tr_b16 v[244:245], v40 offset:4096
    ds_read_b64_tr_b16 v[246:247], v40 offset:5120
    v_mfma_f32_16x16x32_bf16 v[220:223], v[228:231], v[80:83], v[220:223]
    ds_read_b64_tr_b16 v[248:249], v39 offset:8192
    ds_read_b64_tr_b16 v[250:251], v39 offset:9216
    s_waitcnt lgkmcnt(8)
    v_mfma_f32_16x16x32_bf16 v[164:167], v[232:235], v[84:87], v[164:167]
    v_mov_b32 v18, 9
    ds_max_u32 v17, v18 offset:16
    ds_read_b64_tr_b16 v[252:253], v40 offset:8192
    v_mfma_f32_16x16x32_bf16 v[188:191], v[232:235], v[88:91], v[188:191]
    ds_read_b64_tr_b16 v[254:255], v40 offset:9216
    s_getreg_b32 s84, hwreg(HW_REG_IB_STS)
    s_and_b32 s84, s84, 0xc0000f
    s_or_b32 s84, s84, s53
    s_cbranch_scc0 Lap92
Lab93:
    s_waitcnt lgkmcnt(9)
    v_mfma_f32_16x16x32_bf16 v[168:171], v[236:239], v[84:87], v[168:171]
    ds_read_b128 v[228:231], v47 offset:12288
    v_mfma_f32_16x16x32_bf16 v[192:195], v[236:239], v[88:91], v[192:195]
    s_waitcnt lgkmcnt(8)
    v_mfma_f32_16x16x32_bf16 v[172:175], v[240:243], v[84:87], v[172:175]
    ds_read_b64_tr_b16 v[232:233], v41 offset:4096
    ds_read_b64_tr_b16 v[234:235], v41 offset:5120
    v_mfma_f32_16x16x32_bf16 v[196:199], v[240:243], v[88:91], v[196:199]
    s_waitcnt lgkmcnt(8)
    v_mfma_f32_16x16x32_bf16 v[176:179], v[244:247], v[84:87], v[176:179]
    ds_read_b128 v[236:239], v34 offset:256
    v_mfma_f32_16x16x32_bf16 v[200:203], v[244:247], v[88:91], v[200:203]
    s_waitcnt lgkmcnt(7)
    v_mfma_f32_16x16x32_bf16 v[180:183], v[84:87], v[248:251], v[180:183]
    ds_read_b64_tr_b16 v[240:241], v39 offset:2048
    ds_read_b64_tr_b16 v[242:243], v39 offset:3072
    v_mfma_f32_16x16x32_bf16 v[204:207], v[88:91], v[248:251], v[204:207]
    s_waitcnt lgkmcnt(6)
    v_mfma_f32_16x16x32_bf16 v[184:187], v[84:87], v[252:255], v[184:187]
    ds_read_b64_tr_b16 v[244:245], v40 offset:2048
    ds_read_b64_tr_b16 v[246:247], v40 offset:3072
    v_mfma_f32_16x16x32_bf16 v[208:211], v[88:91], v[252:255], v[208:211]
    s_getreg_b32 s84, hwreg(HW_REG_IB_STS)
    s_and_b32 s84, s84, 0xc0000f
    s_or_b32 s84, s84, s53
    s_cbranch_scc0 Lap94
Lab95:
    s_waitcnt lgkmcnt(5)
    v_mfma_f32_16x16x32_bf16 v[212:215], v[232:235], v[228:231], v[212:215]
    ds_read_b64_tr_b16 v[248:249], v39 offset:6144
    ds_read_b64_tr_b16 v[250:251], v39 offset:7168
    s_waitcnt lgkmcnt(6)
    v_mfma_f32_16x16x32_bf16 v[216:219], v[236:239], v[84:87], v[216:219]
    ds_read_b64_tr_b16 v[252:253], v40 offset:6144
    ds_read_b64_tr_b16 v[254:255], v40 offset:7168
    v_mfma_f32_16x16x32_bf16 v[220:223], v[236:239], v[88:91], v[220:223]
    ds_read_b64_tr_b16 v[228:229], v39 offset:10240
    ds_read_b64_tr_b16 v[230:231], v39 offset:11264
    s_waitcnt lgkmcnt(8)
    v_mfma_f32_16x16x32_bf16 v[164:167], v[240:243], v[92:95], v[164:167]
    ds_read_b64_tr_b16 v[232:233], v40 offset:10240
    ds_read_b64_tr_b16 v[234:235], v40 offset:11264
    v_mfma_f32_16x16x32_bf16 v[188:191], v[240:243], v[96:99], v[188:191]
    s_waitcnt lgkmcnt(8)
    v_mfma_f32_16x16x32_bf16 v[168:171], v[244:247], v[92:95], v[168:171]
    ds_read_b128 v[20:23], v16 offset:0
    ds_read_b128 v[236:239], v48 offset:12288
    v_mfma_f32_16x16x32_bf16 v[192:195], v[244:247], v[96:99], v[192:195]
    s_waitcnt lgkmcnt(8)
    v_mfma_f32_16x16x32_bf16 v[172:175], v[248:251], v[92:95], v[172:175]
    ds_read_b64_tr_b16 v[240:241], v41 offset:6144
    ds_read_b64_tr_b16 v[242:243], v41 offset:7168
    v_mfma_f32_16x16x32_bf16 v[196:199], v[248:251], v[96:99], v[196:199]
    s_waitcnt lgkmcnt(8)
    v_mfma_f32_16x16x32_bf16 v[176:179], v[252:255], v[92:95], v[176:179]
    ds_read_b128 v[244:247], v34 offset:320
    v_mfma_f32_16x16x32_bf16 v[200:203], v[252:255], v[96:99], v[200:203]
    s_getreg_b32 s84, hwreg(HW_REG_IB_STS)
    s_and_b32 s84, s84, 0xc0000f
    s_or_b32 s84, s84, s53
    s_cbranch_scc0 Lap96
Lab97:
    s_waitcnt lgkmcnt(7)
    v_mfma_f32_16x16x32_bf16 v[180:183], v[92:95], v[228:231], v[180:183]
    s_waitcnt lgkmcnt(4)
    v_min_u32 v20, v20, v21
    s_nop 0
    v_readfirstlane_b32 s85, v20
    s_cmp_ge_u32 s85, 18
    s_cbranch_scc0 Las72
Lak73:
    v_mfma_f32_16x16x32_bf16 v[204:207], v[96:99], v[228:231], v[204:207]
    ds_read_b64_tr_b16 v[248:249], v36 offset:16384
    ds_read_b64_tr_b16 v[250:251], v36 offset:17408
    v_mfma_f32_16x16x32_bf16 v[184:187], v[92:95], v[232:235], v[184:187]
    ds_read_b64_tr_b16 v[252:253], v37 offset:16384
    ds_read_b64_tr_b16 v[254:255], v37 offset:17408
    v_mfma_f32_16x16x32_bf16 v[208:211], v[96:99], v[232:235], v[208:211]
    s_waitcnt lgkmcnt(5)
    v_mfma_f32_16x16x32_bf16 v[212:215], v[240:243], v[236:239], v[212:215]
    ds_read_b64_tr_b16 v[228:229], v36 offset:20480
    ds_read_b64_tr_b16 v[230:231], v36 offset:21504
    s_waitcnt lgkmcnt(6)
    v_mfma_f32_16x16x32_bf16 v[216:219], v[244:247], v[92:95], v[216:219]
    ds_read_b64_tr_b16 v[232:233], v37 offset:20480
    ds_read_b64_tr_b16 v[234:235], v37 offset:21504
    v_mfma_f32_16x16x32_bf16 v[220:223], v[244:247], v[96:99], v[220:223]
    ds_read_b64_tr_b16 v[236:237], v36 offset:24576
    ds_read_b64_tr_b16 v[238:239], v36 offset:25600
    s_waitcnt lgkmcnt(8)
    v_mfma_f32_16x16x32_bf16 v[164:167], v[248:251], v[100:103], v[164:167]
    v_mov_b32 v18, 10
    ds_max_u32 v17, v18 offset:16
    ds_read_b64_tr_b16 v[240:241], v37 offset:24576
    v_mfma_f32_16x16x32_bf16 v[188:191], v[248:251], v[104:107], v[188:191]
    ds_read_b64_tr_b16 v[242:243], v37 offset:25600
    s_getreg_b32 s84, hwreg(HW_REG_IB_STS)
    s_and_b32 s84, s84, 0xc0000f
    s_or_b32 s84, s84, s53
    s_cbranch_scc0 Lap98
Lab99:
    s_waitcnt lgkmcnt(9)
    v_mfma_f32_16x16x32_bf16 v[168:171], v[252:255], v[100:103], v[168:171]
    ds_read_b128 v[244:247], v45 offset:28672
    v_mfma_f32_16x16x32_bf16 v[192:195], v[252:255], v[104:107], v[192:195]
    s_waitcnt lgkmcnt(8)
    v_mfma_f32_16x16x32_bf16 v[172:175], v[228:231], v[100:103], v[172:175]
    ds_read_b64_tr_b16 v[248:249], v38 offset:20480
    ds_read_b64_tr_b16 v[250:251], v38 offset:21504
    v_mfma_f32_16x16x32_bf16 v[196:199], v[228:231], v[104:107], v[196:199]
    s_waitcnt lgkmcnt(8)
    v_mfma_f32_16x16x32_bf16 v[176:179], v[232:235], v[100:103], v[176:179]
    ds_read_b128 v[252:255], v34 offset:384
    v_mfma_f32_16x16x32_bf16 v[200:203], v[232:235], v[104:107], v[200:203]
    s_waitcnt lgkmcnt(7)
    v_mfma_f32_16x16x32_bf16 v[180:183], v[100:103], v[236:239], v[180:183]
    ds_read_b64_tr_b16 v[228:229], v36 offset:18432
    ds_read_b64_tr_b16 v[230:231], v36 offset:19456
    v_mfma_f32_16x16x32_bf16 v[204:207], v[104:107], v[236:239], v[204:207]
    s_waitcnt lgkmcnt(6)
    v_mfma_f32_16x16x32_bf16 v[184:187], v[100:103], v[240:243], v[184:187]
    ds_read_b64_tr_b16 v[232:233], v37 offset:18432
    ds_read_b64_tr_b16 v[234:235], v37 offset:19456
    v_mfma_f32_16x16x32_bf16 v[208:211], v[104:107], v[240:243], v[208:211]
    s_getreg_b32 s84, hwreg(HW_REG_IB_STS)
    s_and_b32 s84, s84, 0xc0000f
    s_or_b32 s84, s84, s53
    s_cbranch_scc0 Lap100
Lab101:
    s_waitcnt lgkmcnt(5)
    v_mfma_f32_16x16x32_bf16 v[212:215], v[248:251], v[244:247], v[212:215]
    ds_read_b64_tr_b16 v[236:237], v36 offset:22528
    ds_read_b64_tr_b16 v[238:239], v36 offset:23552
    s_waitcnt lgkmcnt(6)
    v_mfma_f32_16x16x32_bf16 v[216:219], v[252:255], v[100:103], v[216:219]
    ds_read_b64_tr_b16 v[240:241], v37 offset:22528
    ds_read_b64_tr_b16 v[242:243], v37 offset:23552
    v_mfma_f32_16x16x32_bf16 v[220:223], v[252:255], v[104:107], v[220:223]
    ds_read_b64_tr_b16 v[244:245], v36 offset:26624
    ds_read_b64_tr_b16 v[246:247], v36 offset:27648
    s_waitcnt lgkmcnt(8)
    v_mfma_f32_16x16x32_bf16 v[164:167], v[228:231], v[108:111], v[164:167]
    ds_read_b64_tr_b16 v[248:249], v37 offset:26624
    ds_read_b64_tr_b16 v[250:251], v37 offset:27648
    v_mfma_f32_16x16x32_bf16 v[188:191], v[228:231], v[112:115], v[188:191]
    s_waitcnt lgkmcnt(8)
    v_mfma_f32_16x16x32_bf16 v[168:171], v[232:235], v[108:111], v[168:171]
    ds_read_b128 v[20:23], v16 offset:0
    ds_read_b128 v[252:255], v46 offset:28672
    v_mfma_f32_16x16x32_bf16 v[192:195], v[232:235], v[112:115], v[192:195]
    s_waitcnt lgkmcnt(8)
    v_mfma_f32_16x16x32_bf16 v[172:175], v[236:239], v[108:111], v[172:175]
    ds_read_b64_tr_b16 v[228:229], v38 offset:22528
    ds_read_b64_tr_b16 v[230:231], v38 offset:23552
    v_mfma_f32_16x16x32_bf16 v[196:199], v[236:239], v[112:115], v[196:199]
    s_waitcnt lgkmcnt(8)
    v_mfma_f32_16x16x32_bf16 v[176:179], v[240:243], v[108:111], v[176:179]
    ds_read_b128 v[232:235], v34 offset:448
    v_mfma_f32_16x16x32_bf16 v[200:203], v[240:243], v[112:115], v[200:203]
    s_getreg_b32 s84, hwreg(HW_REG_IB_STS)
    s_and_b32 s84, s84, 0xc0000f
    s_or_b32 s84, s84, s53
    s_cbranch_scc0 Lap102
Lab103:
    s_waitcnt lgkmcnt(7)
    v_mfma_f32_16x16x32_bf16 v[180:183], v[108:111], v[244:247], v[180:183]
    s_waitcnt lgkmcnt(4)
    v_min_u32 v20, v20, v21
    s_nop 0
    v_readfirstlane_b32 s85, v20
    s_cmp_ge_u32 s85, 19
    s_cbranch_scc0 Las74
Lak75:
    v_mfma_f32_16x16x32_bf16 v[204:207], v[112:115], v[244:247], v[204:207]
    ds_read_b64_tr_b16 v[236:237], v39 offset:16384
    ds_read_b64_tr_b16 v[238:239], v39 offset:17408
    v_mfma_f32_16x16x32_bf16 v[184:187], v[108:111], v[248:251], v[184:187]
    ds_read_b64_tr_b16 v[240:241], v40 offset:16384
    ds_read_b64_tr_b16 v[242:243], v40 offset:17408
    v_mfma_f32_16x16x32_bf16 v[208:211], v[112:115], v[248:251], v[208:211]
    s_waitcnt lgkmcnt(5)
    v_mfma_f32_16x16x32_bf16 v[212:215], v[228:231], v[252:255], v[212:215]
    ds_read_b64_tr_b16 v[244:245], v39 offset:20480
    ds_read_b64_tr_b16 v[246:247], v39 offset:21504
    s_waitcnt lgkmcnt(6)
    v_mfma_f32_16x16x32_bf16 v[216:219], v[232:235], v[108:111], v[216:219]
    ds_read_b64_tr_b16 v[248:249], v40 offset:20480
    ds_read_b64_tr_b16 v[250:251], v40 offset:21504
    v_mfma_f32_16x16x32_bf16 v[220:223], v[232:235], v[112:115], v[220:223]
    ds_read_b64_tr_b16 v[252:253], v39 offset:24576
    ds_read_b64_tr_b16 v[254:255], v39 offset:25600
    s_waitcnt lgkmcnt(8)
    v_mfma_f32_16x16x32_bf16 v[164:167], v[236:239], v[116:119], v[164:167]
    v_mov_b32 v18, 11
    ds_max_u32 v17, v18 offset:16
    ds_read_b64_tr_b16 v[228:229], v40 offset:24576
    v_mfma_f32_16x16x32_bf16 v[188:191], v[236:239], v[120:123], v[188:191]
    ds_read_b64_tr_b16 v[230:231], v40 offset:25600
    s_getreg_b32 s84, hwreg(HW_REG_IB_STS)
    s_and_b32 s84, s84, 0xc0000f
    s_or_b32 s84, s84, s53
    s_cbranch_scc0 Lap104
Lab105:
    s_waitcnt lgkmcnt(9)
    v_mfma_f32_16x16x32_bf16 v[168:171], v[240:243], v[116:119], v[168:171]
    ds_read_b128 v[232:235], v47 offset:28672
    v_mfma_f32_16x16x32_bf16 v[192:195], v[240:243], v[120:123], v[192:195]
    s_waitcnt lgkmcnt(8)
    v_mfma_f32_16x16x32_bf16 v[172:175], v[244:247], v[116:119], v[172:175]
    ds_read_b64_tr_b16 v[236:237], v41 offset:20480
    ds_read_b64_tr_b16 v[238:239], v41 offset:21504
    v_mfma_f32_16x16x32_bf16 v[196:199], v[244:247], v[120:123], v[196:199]
    s_waitcnt lgkmcnt(8)
    v_mfma_f32_16x16x32_bf16 v[176:179], v[248:251], v[116:119], v[176:179]
    ds_read_b128 v[240:243], v34 offset:512
    v_mfma_f32_16x16x32_bf16 v[200:203], v[248:251], v[120:123], v[200:203]
    s_waitcnt lgkmcnt(7)
    v_mfma_f32_16x16x32_bf16 v[180:183], v[116:119], v[252:255], v[180:183]
    ds_read_b64_tr_b16 v[244:245], v39 offset:18432
    ds_read_b64_tr_b16 v[246:247], v39 offset:19456
    v_mfma_f32_16x16x32_bf16 v[204:207], v[120:123], v[252:255], v[204:207]
    s_waitcnt lgkmcnt(6)
    v_mfma_f32_16x16x32_bf16 v[184:187], v[116:119], v[228:231], v[184:187]
    ds_read_b64_tr_b16 v[248:249], v40 offset:18432
    ds_read_b64_tr_b16 v[250:251], v40 offset:19456
    v_mfma_f32_16x16x32_bf16 v[208:211], v[120:123], v[228:231], v[208:211]
    s_getreg_b32 s84, hwreg(HW_REG_IB_STS)
    s_and_b32 s84, s84, 0xc0000f
    s_or_b32 s84, s84, s53
    s_cbranch_scc0 Lap106
Lab107:
    s_waitcnt lgkmcnt(5)
    v_mfma_f32_16x16x32_bf16 v[212:215], v[236:239], v[232:235], v[212:215]
    ds_read_b64_tr_b16 v[252:253], v39 offset:22528
    ds_read_b64_tr_b16 v[254:255], v39 offset:23552
    s_waitcnt lgkmcnt(6)
    v_mfma_f32_16x16x32_bf16 v[216:219], v[240:243], v[116:119], v[216:219]
    ds_read_b64_tr_b16 v[228:229], v40 offset:22528
    ds_read_b64_tr_b16 v[230:231], v40 offset:23552
    v_mfma_f32_16x16x32_bf16 v[220:223], v[240:243], v[120:123], v[220:223]
    ds_read_b64_tr_b16 v[232:233], v39 offset:26624
    ds_read_b64_tr_b16 v[234:235], v39 offset:27648
    s_waitcnt lgkmcnt(8)
    v_mfma_f32_16x16x32_bf16 v[164:167], v[244:247], v[124:127], v[164:167]
    ds_read_b64_tr_b16 v[236:237], v40 offset:26624
    ds_read_b64_tr_b16 v[238:239], v40 offset:27648
    v_mfma_f32_16x16x32_bf16 v[188:191], v[244:247], v[128:131], v[188:191]
    s_waitcnt lgkmcnt(8)
    v_mfma_f32_16x16x32_bf16 v[168:171], v[248:251], v[124:127], v[168:171]
    ds_read_b128 v[20:23], v16 offset:0
    ds_read_b128 v[240:243], v48 offset:28672
    v_mfma_f32_16x16x32_bf16 v[192:195], v[248:251], v[128:131], v[192:195]
    s_waitcnt lgkmcnt(8)
    v_mfma_f32_16x16x32_bf16 v[172:175], v[252:255], v[124:127], v[172:175]
    ds_read_b64_tr_b16 v[244:245], v41 offset:22528
    ds_read_b64_tr_b16 v[246:247], v41 offset:23552
    v_mfma_f32_16x16x32_bf16 v[196:199], v[252:255], v[128:131], v[196:199]
    s_waitcnt lgkmcnt(8)
    v_mfma_f32_16x16x32_bf16 v[176:179], v[228:231], v[124:127], v[176:179]
    ds_read_b128 v[248:251], v34 offset:576
    v_mfma_f32_16x16x32_bf16 v[200:203], v[228:231], v[128:131], v[200:203]
    s_getreg_b32 s84, hwreg(HW_REG_IB_STS)
    s_and_b32 s84, s84, 0xc0000f
    s_or_b32 s84, s84, s53
    s_cbranch_scc0 Lap108
Lab109:
    s_waitcnt lgkmcnt(7)
    v_mfma_f32_16x16x32_bf16 v[180:183], v[124:127], v[232:235], v[180:183]
    s_waitcnt lgkmcnt(4)
    v_min_u32 v20, v20, v21
    s_nop 0
    v_readfirstlane_b32 s85, v20
    s_cmp_ge_u32 s85, 20
    s_cbranch_scc0 Las76
Lak77:
    v_mfma_f32_16x16x32_bf16 v[204:207], v[128:131], v[232:235], v[204:207]
    ds_read_b64_tr_b16 v[252:253], v36 offset:32768
    ds_read_b64_tr_b16 v[254:255], v36 offset:33792
    v_mfma_f32_16x16x32_bf16 v[184:187], v[124:127], v[236:239], v[184:187]
    ds_read_b64_tr_b16 v[228:229], v37 offset:32768
    ds_read_b64_tr_b16 v[230:231], v37 offset:33792
    v_mfma_f32_16x16x32_bf16 v[208:211], v[128:131], v[236:239], v[208:211]
    s_waitcnt lgkmcnt(5)
    v_mfma_f32_16x16x32_bf16 v[212:215], v[244:247], v[240:243], v[212:215]
    ds_read_b64_tr_b16 v[232:233], v36 offset:36864
    ds_read_b64_tr_b16 v[234:235], v36 offset:37888
    s_waitcnt lgkmcnt(6)
    v_mfma_f32_16x16x32_bf16 v[216:219], v[248:251], v[124:127], v[216:219]
    ds_read_b64_tr_b16 v[236:237], v37 offset:36864
    ds_read_b64_tr_b16 v[238:239], v37 offset:37888
    v_mfma_f32_16x16x32_bf16 v[220:223], v[248:251], v[128:131], v[220:223]
    ds_read_b64_tr_b16 v[240:241], v36 offset:40960
    ds_read_b64_tr_b16 v[242:243], v36 offset:41984
    s_waitcnt lgkmcnt(8)
    v_mfma_f32_16x16x32_bf16 v[164:167], v[252:255], v[132:135], v[164:167]
    v_mov_b32 v18, 12
    ds_max_u32 v17, v18 offset:16
    ds_read_b64_tr_b16 v[244:245], v37 offset:40960
    v_mfma_f32_16x16x32_bf16 v[188:191], v[252:255], v[136:139], v[188:191]
    ds_read_b64_tr_b16 v[246:247], v37 offset:41984
    s_getreg_b32 s84, hwreg(HW_REG_IB_STS)
    s_and_b32 s84, s84, 0xc0000f
    s_or_b32 s84, s84, s53
    s_cbranch_scc0 Lap110
Lab111:
    s_waitcnt lgkmcnt(9)
    v_mfma_f32_16x16x32_bf16 v[168:171], v[228:231], v[132:135], v[168:171]
    ds_read_b128 v[248:251], v45 offset:45056
    v_mfma_f32_16x16x32_bf16 v[192:195], v[228:231], v[136:139], v[192:195]
    s_waitcnt lgkmcnt(8)
    v_mfma_f32_16x16x32_bf16 v[172:175], v[232:235], v[132:135], v[172:175]
    ds_read_b64_tr_b16 v[252:253], v38 offset:36864
    ds_read_b64_tr_b16 v[254:255], v38 offset:37888
    v_mfma_f32_16x16x32_bf16 v[196:199], v[232:235], v[136:139], v[196:199]
    s_waitcnt lgkmcnt(8)
    v_mfma_f32_16x16x32_bf16 v[176:179], v[236:239], v[132:135], v[176:179]
    ds_read_b128 v[228:231], v34 offset:640
    v_mfma_f32_16x16x32_bf16 v[200:203], v[236:239], v[136:139], v[200:203]
    s_waitcnt lgkmcnt(7)
    v_mfma_f32_16x16x32_bf16 v[180:183], v[132:135], v[240:243], v[180:183]
    ds_read_b64_tr_b16 v[232:233], v36 offset:34816
    ds_read_b64_tr_b16 v[234:235], v36 offset:35840
    v_mfma_f32_16x16x32_bf16 v[204:207], v[136:139], v[240:243], v[204:207]
    s_waitcnt lgkmcnt(6)
    v_mfma_f32_16x16x32_bf16 v[184:187], v[132:135], v[244:247], v[184:187]
    ds_read_b64_tr_b16 v[236:237], v37 offset:34816
    ds_read_b64_tr_b16 v[238:239], v37 offset:35840
    v_mfma_f32_16x16x32_bf16 v[208:211], v[136:139], v[244:247], v[208:211]
    s_getreg_b32 s84, hwreg(HW_REG_IB_STS)
    s_and_b32 s84, s84, 0xc0000f
    s_or_b32 s84, s84, s53
    s_cbranch_scc0 Lap112
Lab113:
    s_waitcnt lgkmcnt(5)
    v_mfma_f32_16x16x32_bf16 v[212:215], v[252:255], v[248:251], v[212:215]
    ds_read_b64_tr_b16 v[240:241], v36 offset:38912
    ds_read_b64_tr_b16 v[242:243], v36 offset:39936
    s_waitcnt lgkmcnt(6)
    v_mfma_f32_16x16x32_bf16 v[216:219], v[228:231], v[132:135], v[216:219]
    ds_read_b64_tr_b16 v[244:245], v37 offset:38912
    ds_read_b64_tr_b16 v[246:247], v37 offset:39936
    v_mfma_f32_16x16x32_bf16 v[220:223], v[228:231], v[136:139], v[220:223]
    ds_read_b64_tr_b16 v[248:249], v36 offset:43008
    ds_read_b64_tr_b16 v[250:251], v36 offset:44032
    s_waitcnt lgkmcnt(8)
    v_mfma_f32_16x16x32_bf16 v[164:167], v[232:235], v[140:143], v[164:167]
    ds_read_b64_tr_b16 v[252:253], v37 offset:43008
    ds_read_b64_tr_b16 v[254:255], v37 offset:44032
    v_mfma_f32_16x16x32_bf16 v[188:191], v[232:235], v[144:147], v[188:191]
    s_waitcnt lgkmcnt(8)
    v_mfma_f32_16x16x32_bf16 v[168:171], v[236:239], v[140:143], v[168:171]
    ds_read_b128 v[20:23], v16 offset:0
    ds_read_b128 v[228:231], v46 offset:45056
    v_mfma_f32_16x16x32_bf16 v[192:195], v[236:239], v[144:147], v[192:195]
    s_waitcnt lgkmcnt(8)
    v_mfma_f32_16x16x32_bf16 v[172:175], v[240:243], v[140:143], v[172:175]
    ds_read_b64_tr_b16 v[232:233], v38 offset:38912
    ds_read_b64_tr_b16 v[234:235], v38 offset:39936
    v_mfma_f32_16x16x32_bf16 v[196:199], v[240:243], v[144:147], v[196:199]
    s_waitcnt lgkmcnt(8)
    v_mfma_f32_16x16x32_bf16 v[176:179], v[244:247], v[140:143], v[176:179]
    ds_read_b128 v[236:239], v34 offset:704
    v_mfma_f32_16x16x32_bf16 v[200:203], v[244:247], v[144:147], v[200:203]
    s_getreg_b32 s84, hwreg(HW_REG_IB_STS)
    s_and_b32 s84, s84, 0xc0000f
    s_or_b32 s84, s84, s53
    s_cbranch_scc0 Lap114
Lab115:
    s_waitcnt lgkmcnt(7)
    v_mfma_f32_16x16x32_bf16 v[180:183], v[140:143], v[248:251], v[180:183]
    s_waitcnt lgkmcnt(4)
    v_min_u32 v20, v20, v21
    s_nop 0
    v_readfirstlane_b32 s85, v20
    s_cmp_ge_u32 s85, 21
    s_cbranch_scc0 Las78
Lak79:
    v_mfma_f32_16x16x32_bf16 v[204:207], v[144:147], v[248:251], v[204:207]
    ds_read_b64_tr_b16 v[240:241], v39 offset:32768
    ds_read_b64_tr_b16 v[242:243], v39 offset:33792
    v_mfma_f32_16x16x32_bf16 v[184:187], v[140:143], v[252:255], v[184:187]
    ds_read_b64_tr_b16 v[244:245], v40 offset:32768
    ds_read_b64_tr_b16 v[246:247], v40 offset:33792
    v_mfma_f32_16x16x32_bf16 v[208:211], v[144:147], v[252:255], v[208:211]
    s_waitcnt lgkmcnt(5)
    v_mfma_f32_16x16x32_bf16 v[212:215], v[232:235], v[228:231], v[212:215]
    ds_read_b64_tr_b16 v[248:249], v39 offset:36864
    ds_read_b64_tr_b16 v[250:251], v39 offset:37888
    s_waitcnt lgkmcnt(6)
    v_mfma_f32_16x16x32_bf16 v[216:219], v[236:239], v[140:143], v[216:219]
    ds_read_b64_tr_b16 v[252:253], v40 offset:36864
    ds_read_b64_tr_b16 v[254:255], v40 offset:37888
    v_mfma_f32_16x16x32_bf16 v[220:223], v[236:239], v[144:147], v[220:223]
    ds_read_b64_tr_b16 v[228:229], v39 offset:40960
    ds_read_b64_tr_b16 v[230:231], v39 offset:41984
    s_waitcnt lgkmcnt(8)
    v_mfma_f32_16x16x32_bf16 v[164:167], v[240:243], v[148:151], v[164:167]
    v_mov_b32 v18, 13
    ds_max_u32 v17, v18 offset:16
    ds_read_b64_tr_b16 v[232:233], v40 offset:40960
    v_mfma_f32_16x16x32_bf16 v[188:191], v[240:243], v[152:155], v[188:191]
    ds_read_b64_tr_b16 v[234:235], v40 offset:41984
    s_getreg_b32 s84, hwreg(HW_REG_IB_STS)
    s_and_b32 s84, s84, 0xc0000f
    s_or_b32 s84, s84, s53
    s_cbranch_scc0 Lap116
Lab117:
    s_waitcnt lgkmcnt(9)
    v_mfma_f32_16x16x32_bf16 v[168:171], v[244:247], v[148:151], v[168:171]
    ds_read_b128 v[236:239], v47 offset:45056
    v_mfma_f32_16x16x32_bf16 v[192:195], v[244:247], v[152:155], v[192:195]
    s_waitcnt lgkmcnt(8)
    v_mfma_f32_16x16x32_bf16 v[172:175], v[248:251], v[148:151], v[172:175]
    ds_read_b64_tr_b16 v[240:241], v41 offset:36864
    ds_read_b64_tr_b16 v[242:243], v41 offset:37888
    v_mfma_f32_16x16x32_bf16 v[196:199], v[248:251], v[152:155], v[196:199]
    s_waitcnt lgkmcnt(8)
    v_mfma_f32_16x16x32_bf16 v[176:179], v[252:255], v[148:151], v[176:179]
    ds_read_b128 v[244:247], v34 offset:768
    v_mfma_f32_16x16x32_bf16 v[200:203], v[252:255], v[152:155], v[200:203]
    s_waitcnt lgkmcnt(7)
    v_mfma_f32_16x16x32_bf16 v[180:183], v[148:151], v[228:231], v[180:183]
    ds_read_b64_tr_b16 v[248:249], v39 offset:34816
    ds_read_b64_tr_b16 v[250:251], v39 offset:35840
    v_mfma_f32_16x16x32_bf16 v[204:207], v[152:155], v[228:231], v[204:207]
    s_waitcnt lgkmcnt(6)
    v_mfma_f32_16x16x32_bf16 v[184:187], v[148:151], v[232:235], v[184:187]
    ds_read_b64_tr_b16 v[252:253], v40 offset:34816
    ds_read_b64_tr_b16 v[254:255], v40 offset:35840
    v_mfma_f32_16x16x32_bf16 v[208:211], v[152:155], v[232:235], v[208:211]
    s_getreg_b32 s84, hwreg(HW_REG_IB_STS)
    s_and_b32 s84, s84, 0xc0000f
    s_or_b32 s84, s84, s53
    s_cbranch_scc0 Lap118
Lab119:
    s_waitcnt lgkmcnt(5)
    v_mfma_f32_16x16x32_bf16 v[212:215], v[240:243], v[236:239], v[212:215]
    ds_read_b64_tr_b16 v[228:229], v39 offset:38912
    ds_read_b64_tr_b16 v[230:231], v39 offset:39936
    s_waitcnt lgkmcnt(6)
    v_mfma_f32_16x16x32_bf16 v[216:219], v[244:247], v[148:151], v[216:219]
    ds_read_b64_tr_b16 v[232:233], v40 offset:38912
    ds_read_b64_tr_b16 v[234:235], v40 offset:39936
    v_mfma_f32_16x16x32_bf16 v[220:223], v[244:247], v[152:155], v[220:223]
    ds_read_b64_tr_b16 v[236:237], v39 offset:43008
    ds_read_b64_tr_b16 v[238:239], v39 offset:44032
    s_waitcnt lgkmcnt(8)
    v_mfma_f32_16x16x32_bf16 v[164:167], v[248:251], v[156:159], v[164:167]
    ds_read_b64_tr_b16 v[240:241], v40 offset:43008
    ds_read_b64_tr_b16 v[242:243], v40 offset:44032
    v_mfma_f32_16x16x32_bf16 v[188:191], v[248:251], v[160:163], v[188:191]
    s_waitcnt lgkmcnt(8)
    v_mfma_f32_16x16x32_bf16 v[168:171], v[252:255], v[156:159], v[168:171]
    ds_read_b128 v[244:247], v48 offset:45056
    v_mfma_f32_16x16x32_bf16 v[192:195], v[252:255], v[160:163], v[192:195]
    s_waitcnt lgkmcnt(7)
    v_mfma_f32_16x16x32_bf16 v[172:175], v[228:231], v[156:159], v[172:175]
    ds_read_b64_tr_b16 v[248:249], v41 offset:38912
    ds_read_b64_tr_b16 v[250:251], v41 offset:39936
    v_mfma_f32_16x16x32_bf16 v[196:199], v[228:231], v[160:163], v[196:199]
    s_waitcnt lgkmcnt(7)
    v_mfma_f32_16x16x32_bf16 v[176:179], v[232:235], v[156:159], v[176:179]
    ds_read_b128 v[252:255], v34 offset:832
    v_mfma_f32_16x16x32_bf16 v[200:203], v[232:235], v[160:163], v[200:203]
    s_getreg_b32 s84, hwreg(HW_REG_IB_STS)
    s_and_b32 s84, s84, 0xc0000f
    s_or_b32 s84, s84, s53
    s_cbranch_scc0 Lap120
Lab121:
    s_waitcnt lgkmcnt(6)
    v_mfma_f32_16x16x32_bf16 v[180:183], v[156:159], v[236:239], v[180:183]
    v_mfma_f32_16x16x32_bf16 v[204:207], v[160:163], v[236:239], v[204:207]
    s_waitcnt lgkmcnt(4)
    v_mfma_f32_16x16x32_bf16 v[184:187], v[156:159], v[240:243], v[184:187]
    v_mfma_f32_16x16x32_bf16 v[208:211], v[160:163], v[240:243], v[208:211]
    s_waitcnt lgkmcnt(1)
    v_mfma_f32_16x16x32_bf16 v[212:215], v[248:251], v[244:247], v[212:215]
    s_waitcnt lgkmcnt(0)
    v_mfma_f32_16x16x32_bf16 v[216:219], v[252:255], v[156:159], v[216:219]
    v_mfma_f32_16x16x32_bf16 v[220:223], v[252:255], v[160:163], v[220:223]
    v_mov_b32 v18, 14
    ds_max_u32 v17, v18 offset:16
    s_cmp_lg_u32 s53, 0
    s_cbranch_scc1 Lpd122
    s_waitcnt vmcnt(0)
    v_mov_b32 v6, s82
    v_mov_b32 v7, s83
    s_add_u32 s84, s49, 0
    s_mov_b64 exec, 1
    buffer_store_dwordx2 v[6:7], v4, s[20:23], s84 offen sc1
    s_mov_b64 exec, -1
Lpd122:
    ds_read_b128 v[20:23], v16 offset:16
    s_lshl_b32 s84, s86, 11
    s_add_u32 s84, s84, 131072
    v_add_u32 v86, s84, v2
    v_add_u32 v87, s84, v5
    v_cvt_pk_bf16_f32 v60, v196, v197
    v_cvt_pk_bf16_f32 v61, v198, v199
    v_cvt_pk_bf16_f32 v62, v200, v201
    v_cvt_pk_bf16_f32 v63, v202, v203
    v_cvt_pk_bf16_f32 v76, v204, v205
    v_cvt_pk_bf16_f32 v77, v206, v207
    v_cvt_pk_bf16_f32 v82, v208, v209
    v_cvt_pk_bf16_f32 v83, v210, v211
    s_waitcnt lgkmcnt(0)
Llw123:
    v_min3_u32 v20, v20, v21, v22
    v_min_u32 v20, v20, v23
    s_nop 0
    v_readfirstlane_b32 s85, v20
    s_cmp_ge_u32 s85, 8
    s_cbranch_scc1 Llk124
    s_sleep 1
    ds_read_b128 v[20:23], v16 offset:16
    s_waitcnt lgkmcnt(0)
    s_add_u32 s92, s92, 1
    s_cmp_lt_u32 s92, 0x200000
    s_cbranch_scc1 Llw123
Llk124:
    v_cvt_pk_bf16_f32 v84, v212, v213
    v_cvt_pk_bf16_f32 v85, v214, v215
    ds_write_b128 v86, v[60:63] offset:2048
    ds_write_b64 v87, v[76:77] offset:3072
    ds_write_b64 v87, v[82:83] offset:3584
    s_cmp_ge_u32 s86, 2
    s_cbranch_scc1 gated_mix__sliding_local_dilated__dense_activation_squared_relu__prompt_kernel_hv
    s_lshl_b32 s84, s86, 3
    s_add_u32 s84, s84, 131072
    v_add_u32 v88, s84, v2
    ds_write_b64 v88, v[84:85]
    s_branch gated_mix__sliding_local_dilated__dense_activation_squared_relu__prompt_kernel_hd
gated_mix__sliding_local_dilated__dense_activation_squared_relu__prompt_kernel_hv:
    s_and_b32 s84, s86, 1
    s_lshl_b32 s84, s84, 9
    s_add_u32 s84, s84, 132096
    v_bfe_u32 v88, v1, 2, 2
    v_lshlrev_b32 v88, 7, v88
    v_lshl_add_u32 v88, v9, 5, v88
    v_lshl_add_u32 v88, v12, 1, v88
    v_add_u32 v88, s84, v88
    ds_write_b16 v88, v84
    ds_write_b16_d16_hi v88, v84 offset:8
    ds_write_b16 v88, v85 offset:16
    ds_write_b16_d16_hi v88, v85 offset:24
gated_mix__sliding_local_dilated__dense_activation_squared_relu__prompt_kernel_hd:
    v_mov_b32 v18, 1
    ds_max_u32 v17, v18 offset:32
    v_cmp_eq_u32 vcc, 3, v9
    v_mov_b32 v156, 0x0c0c0100
    v_mov_b32 v157, 0x01000c0c
    v_mov_b32 v158, 0x0c0c0c0c
    v_cndmask_b32 v148, -1, 0, vcc
    v_cndmask_b32 v156, v156, v157, s[72:73]
    v_cndmask_b32 v149, v156, v158, s[74:75]
    v_cndmask_b32 v151, v158, v156, s[74:75]
    v_mov_b32 v156, 0x0c0c0302
    v_mov_b32 v157, 0x03020c0c
    v_cndmask_b32 v156, v156, v157, s[72:73]
    v_cndmask_b32 v150, v156, v158, s[76:77]
    v_cndmask_b32 v152, v158, v156, s[76:77]
    v_mul_f32 v216, 0xbfb8aa3b, v216
    v_mul_f32 v220, 0xbfb8aa3b, v220
    v_exp_f32 v216, v216
    v_exp_f32 v220, v220
    v_lshrrev_b32 v217, 1, v5
    v_add_f32 v216, 1.0, v216
    v_add_f32 v220, 1.0, v220
    v_rcp_f32 v216, v216
    v_rcp_f32 v220, v220
    v_cvt_pk_bf16_f32 v56, v172, v173
    v_cvt_pk_bf16_f32 v57, v174, v175
    v_cvt_pk_bf16_f32 v58, v176, v177
    v_cvt_pk_bf16_f32 v59, v178, v179
    v_cvt_pk_bf16_f32 v74, v180, v181
    v_cvt_pk_bf16_f32 v75, v182, v183
    v_cvt_pk_bf16_f32 v80, v184, v185
    v_cvt_pk_bf16_f32 v81, v186, v187
    s_cmp_lg_u32 s5, 2
    s_cbranch_scc1 Lg125
    s_mov_b64 exec, 0xffff
    buffer_store_dword v216, v217, s[20:23], s50 offen offset:0 sc1
    buffer_store_dword v220, v217, s[20:23], s50 offen offset:64 sc1
    s_mov_b64 exec, -1
Lg125:
    v_cvt_pk_bf16_f32 v68, v188, v189
    v_cvt_pk_bf16_f32 v69, v190, v191
    v_cvt_pk_bf16_f32 v70, v192, v193
    v_cvt_pk_bf16_f32 v71, v194, v195
    v_and_b32 v70, v148, v70
    v_and_b32 v71, v148, v71
    v_cvt_pk_bf16_f32 v64, v164, v165
    v_cvt_pk_bf16_f32 v65, v166, v167
    v_cvt_pk_bf16_f32 v66, v168, v169
    v_cvt_pk_bf16_f32 v67, v170, v171
    v_and_b32 v66, v148, v66
    v_and_b32 v67, v148, v67
    s_waitcnt lgkmcnt(0)
    ds_read_b128 v[20:23], v16 offset:32
    s_waitcnt lgkmcnt(0)
Llw126:
    v_min3_u32 v20, v20, v21, v22
    v_min_u32 v20, v20, v23
    s_nop 0
    v_readfirstlane_b32 s85, v20
    s_cmp_ge_u32 s85, 1
    s_cbranch_scc1 Llk127
    s_sleep 1
    ds_read_b128 v[20:23], v16 offset:32
    s_waitcnt lgkmcnt(0)
    s_add_u32 s92, s92, 1
    s_cmp_lt_u32 s92, 0x200000
    s_cbranch_scc1 Llw126
Llk127:
    ds_read_b128 v[52:55], v86
    ds_read_b64 v[72:73], v87 offset:1024
    ds_read_b64 v[78:79], v87 offset:1536
    s_add_u32 s50, s51, 73728
    v_mfma_f32_16x16x32_bf16 v[100:103], v[56:59], v[68:71], 0
    v_mfma_f32_16x16x32_bf16 v[104:107], v[60:63], v[68:71], 0
    v_mfma_f32_16x16x32_bf16 v[96:99], v[56:59], v[64:67], 0
    s_waitcnt lgkmcnt(0)
    v_mfma_f32_16x16x32_bf16 v[92:95], v[52:55], v[64:67], 0
    v_mov_b32 v156, 0xf149f2ca
    s_nop 4
    v_cndmask_b32 v114, v104, v105, s[72:73]
    v_cndmask_b32 v115, v106, v107, s[72:73]
    v_cndmask_b32 v110, v96, v97, s[72:73]
    v_cndmask_b32 v111, v98, v99, s[72:73]
    v_cndmask_b32 v112, v100, v101, s[72:73]
    v_cndmask_b32 v113, v102, v103, s[72:73]
    v_cndmask_b32 v108, v92, v93, s[72:73]
    v_cndmask_b32 v109, v94, v95, s[72:73]
    v_cndmask_b32 v108, v108, v156, s[78:79]
    v_cndmask_b32 v109, v109, v156, s[78:79]
    v_cndmask_b32 v112, v112, v114, s[74:75]
    v_cndmask_b32 v113, v113, v115, s[76:77]
    v_cndmask_b32 v108, v108, v110, s[74:75]
    v_cndmask_b32 v109, v109, v111, s[76:77]
    v_max_f32 v114, v112, v113
    v_max_f32 v110, v108, v109
    v_mov_b32 v115, v114
    v_mov_b32 v111, v110
    s_nop 0
    v_permlane16_swap_b32 v114, v115
    v_permlane16_swap_b32 v110, v111
    s_nop 0
    v_max_f32 v114, v114, v115
    v_max_f32 v110, v110, v111
    v_mov_b32 v115, v114
    v_mov_b32 v111, v110
    s_nop 0
    v_permlane32_swap_b32 v114, v115
    v_permlane32_swap_b32 v110, v111
    s_nop 0
    v_max_f32 v114, v114, v115
    v_max_f32 v110, v110, v111
    v_sub_f32 v112, v112, v114
    v_sub_f32 v113, v113, v114
    v_sub_f32 v108, v108, v110
    v_sub_f32 v109, v109, v110
    v_mul_f32 v112, 0x3e8b97f6, v112
    v_mul_f32 v113, 0x3e8b97f6, v113
    v_mul_f32 v108, 0x3e8b97f6, v108
    v_mul_f32 v109, 0x3e8b97f6, v109
    v_exp_f32 v112, v112
    v_exp_f32 v113, v113
    v_exp_f32 v108, v108
    v_exp_f32 v109, v109
    s_nop 0
    v_add_f32 v114, v112, v113
    v_add_f32 v110, v108, v109
    v_mov_b32 v115, v114
    v_mov_b32 v111, v110
    s_nop 0
    v_permlane16_swap_b32 v114, v115
    v_permlane16_swap_b32 v110, v111
    s_nop 0
    v_add_f32 v114, v114, v115
    v_add_f32 v110, v110, v111
    v_mov_b32 v115, v114
    v_mov_b32 v111, v110
    s_nop 0
    v_permlane32_swap_b32 v114, v115
    v_permlane32_swap_b32 v110, v111
    s_nop 0
    v_add_f32 v114, v114, v115
    v_add_f32 v110, v110, v111
    v_rcp_f32 v114, v114
    v_rcp_f32 v110, v110
    s_nop 0
    v_mul_f32 v114, v114, v220
    v_mul_f32 v110, v110, v216
    v_mul_f32 v112, v112, v114
    v_mul_f32 v113, v113, v114
    v_mul_f32 v108, v108, v110
    v_mul_f32 v109, v109, v110
    v_cvt_pk_bf16_f32 v112, v112, v113
    v_cvt_pk_bf16_f32 v108, v108, v109
    v_perm_b32 v120, v112, v112, v149
    v_perm_b32 v121, v112, v112, v150
    v_perm_b32 v122, v112, v112, v151
    v_perm_b32 v123, v112, v112, v152
    v_perm_b32 v116, v108, v108, v149
    v_perm_b32 v117, v108, v108, v150
    v_perm_b32 v118, v108, v108, v151
    v_perm_b32 v119, v108, v108, v152
    s_nop 0
    v_mfma_f32_16x16x32_bf16 v[132:135], v[74:77], v[120:123], 0
    v_mfma_f32_16x16x32_bf16 v[136:139], v[80:83], v[120:123], 0
    v_mfma_f32_16x16x32_bf16 v[124:127], v[72:75], v[116:119], 0
    v_mfma_f32_16x16x32_bf16 v[128:131], v[78:81], v[116:119], 0
    s_nop 5
    v_cvt_pk_bf16_f32 v144, v132, v133
    v_cvt_pk_bf16_f32 v145, v134, v135
    v_cvt_pk_bf16_f32 v146, v136, v137
    v_cvt_pk_bf16_f32 v147, v138, v139
    v_and_b32 v146, v148, v146
    v_and_b32 v147, v148, v147
    buffer_store_dwordx4 v[144:147], v2, s[20:23], s50 offen sc1
    v_cvt_pk_bf16_f32 v140, v124, v125
    v_cvt_pk_bf16_f32 v141, v126, v127
    v_cvt_pk_bf16_f32 v142, v128, v129
    v_cvt_pk_bf16_f32 v143, v130, v131
    v_and_b32 v142, v148, v142
    v_and_b32 v143, v148, v143
    buffer_store_dwordx4 v[140:143], v2, s[20:23], s51 offen sc1
    s_waitcnt vmcnt(0)
    v_mov_b32 v6, s82
    v_mov_b32 v7, s83
    s_add_u32 s84, s49, 8192
    s_mov_b64 exec, 1
    buffer_store_dwordx2 v[6:7], v4, s[20:23], s84 offen sc1
    s_mov_b64 exec, -1
    s_endpgm
Las52:
    s_sleep 1
    ds_read_b128 v[20:23], v16
    s_waitcnt lgkmcnt(0)
    v_min_u32 v20, v20, v21
    s_add_u32 s92, s92, 1
    v_readfirstlane_b32 s85, v20
    s_cmp_ge_u32 s85, 4
    s_cbranch_scc1 Lak53
    s_cmp_lt_u32 s92, 0x200000
    s_cbranch_scc1 Las52
    s_branch Lak53
Las54:
    s_sleep 1
    ds_read_b128 v[20:23], v16
    s_waitcnt lgkmcnt(0)
    v_min_u32 v20, v20, v21
    s_add_u32 s92, s92, 1
    v_readfirstlane_b32 s85, v20
    s_cmp_ge_u32 s85, 6
    s_cbranch_scc1 Lak55
    s_cmp_lt_u32 s92, 0x200000
    s_cbranch_scc1 Las54
    s_branch Lak55
Las56:
    s_sleep 1
    ds_read_b128 v[20:23], v16
    s_waitcnt lgkmcnt(0)
    v_min_u32 v20, v20, v21
    s_add_u32 s92, s92, 1
    v_readfirstlane_b32 s85, v20
    s_cmp_ge_u32 s85, 8
    s_cbranch_scc1 Lak57
    s_cmp_lt_u32 s92, 0x200000
    s_cbranch_scc1 Las56
    s_branch Lak57
Las58:
    s_sleep 1
    ds_read_b128 v[20:23], v16
    s_waitcnt lgkmcnt(0)
    v_min_u32 v20, v20, v21
    s_add_u32 s92, s92, 1
    v_readfirstlane_b32 s85, v20
    s_cmp_ge_u32 s85, 10
    s_cbranch_scc1 Lak59
    s_cmp_lt_u32 s92, 0x200000
    s_cbranch_scc1 Las58
    s_branch Lak59
Las60:
    s_sleep 1
    ds_read_b128 v[20:23], v16
    s_waitcnt lgkmcnt(0)
    v_min_u32 v20, v20, v21
    s_add_u32 s92, s92, 1
    v_readfirstlane_b32 s85, v20
    s_cmp_ge_u32 s85, 12
    s_cbranch_scc1 Lak61
    s_cmp_lt_u32 s92, 0x200000
    s_cbranch_scc1 Las60
    s_branch Lak61
Las62:
    s_sleep 1
    ds_read_b128 v[20:23], v16
    s_waitcnt lgkmcnt(0)
    v_min_u32 v20, v20, v21
    s_add_u32 s92, s92, 1
    v_readfirstlane_b32 s85, v20
    s_cmp_ge_u32 s85, 14
    s_cbranch_scc1 Lak63
    s_cmp_lt_u32 s92, 0x200000
    s_cbranch_scc1 Las62
    s_branch Lak63
Lap66:
    s_waitcnt vmcnt(0)
    v_mov_b32 v6, s82
    v_mov_b32 v7, s83
    s_mov_b32 s53, 1
    s_mov_b64 exec, 1
    buffer_store_dwordx2 v[6:7], v4, s[20:23], s49 offen sc1
    s_mov_b64 exec, -1
    s_branch Lab67
Las68:
    s_sleep 1
    ds_read_b128 v[20:23], v16
    s_waitcnt lgkmcnt(0)
    v_min_u32 v20, v20, v21
    s_add_u32 s92, s92, 1
    v_readfirstlane_b32 s85, v20
    s_cmp_ge_u32 s85, 16
    s_cbranch_scc1 Lak69
    s_cmp_lt_u32 s92, 0x200000
    s_cbranch_scc1 Las68
    s_branch Lak69
Las70:
    s_sleep 1
    ds_read_b128 v[20:23], v16
    s_waitcnt lgkmcnt(0)
    v_min_u32 v20, v20, v21
    s_add_u32 s92, s92, 1
    v_readfirstlane_b32 s85, v20
    s_cmp_ge_u32 s85, 17
    s_cbranch_scc1 Lak71
    s_cmp_lt_u32 s92, 0x200000
    s_cbranch_scc1 Las70
    s_branch Lak71
Las72:
    s_sleep 1
    ds_read_b128 v[20:23], v16
    s_waitcnt lgkmcnt(0)
    v_min_u32 v20, v20, v21
    s_add_u32 s92, s92, 1
    v_readfirstlane_b32 s85, v20
    s_cmp_ge_u32 s85, 18
    s_cbranch_scc1 Lak73
    s_cmp_lt_u32 s92, 0x200000
    s_cbranch_scc1 Las72
    s_branch Lak73
Las74:
    s_sleep 1
    ds_read_b128 v[20:23], v16
    s_waitcnt lgkmcnt(0)
    v_min_u32 v20, v20, v21
    s_add_u32 s92, s92, 1
    v_readfirstlane_b32 s85, v20
    s_cmp_ge_u32 s85, 19
    s_cbranch_scc1 Lak75
    s_cmp_lt_u32 s92, 0x200000
    s_cbranch_scc1 Las74
    s_branch Lak75
Las76:
    s_sleep 1
    ds_read_b128 v[20:23], v16
    s_waitcnt lgkmcnt(0)
    v_min_u32 v20, v20, v21
    s_add_u32 s92, s92, 1
    v_readfirstlane_b32 s85, v20
    s_cmp_ge_u32 s85, 20
    s_cbranch_scc1 Lak77
    s_cmp_lt_u32 s92, 0x200000
    s_cbranch_scc1 Las76
    s_branch Lak77
Las78:
    s_sleep 1
    ds_read_b128 v[20:23], v16
    s_waitcnt lgkmcnt(0)
    v_min_u32 v20, v20, v21
    s_add_u32 s92, s92, 1
    v_readfirstlane_b32 s85, v20
    s_cmp_ge_u32 s85, 21
    s_cbranch_scc1 Lak79
    s_cmp_lt_u32 s92, 0x200000
    s_cbranch_scc1 Las78
    s_branch Lak79
Lap82:
    s_waitcnt vmcnt(0)
    v_mov_b32 v6, s82
    v_mov_b32 v7, s83
    s_mov_b32 s53, 1
    s_mov_b64 exec, 1
    buffer_store_dwordx2 v[6:7], v4, s[20:23], s49 offen sc1
    s_mov_b64 exec, -1
    s_branch Lab83
Lap84:
    s_waitcnt vmcnt(0)
    v_mov_b32 v6, s82
    v_mov_b32 v7, s83
    s_mov_b32 s53, 1
    s_mov_b64 exec, 1
    buffer_store_dwordx2 v[6:7], v4, s[20:23], s49 offen sc1
    s_mov_b64 exec, -1
    s_branch Lab85
Lap86:
    s_waitcnt vmcnt(0)
    v_mov_b32 v6, s82
    v_mov_b32 v7, s83
    s_mov_b32 s53, 1
    s_mov_b64 exec, 1
    buffer_store_dwordx2 v[6:7], v4, s[20:23], s49 offen sc1
    s_mov_b64 exec, -1
    s_branch Lab87
Lap88:
    s_waitcnt vmcnt(0)
    v_mov_b32 v6, s82
    v_mov_b32 v7, s83
    s_mov_b32 s53, 1
    s_mov_b64 exec, 1
    buffer_store_dwordx2 v[6:7], v4, s[20:23], s49 offen sc1
    s_mov_b64 exec, -1
    s_branch Lab89
Lap90:
    s_waitcnt vmcnt(0)
    v_mov_b32 v6, s82
    v_mov_b32 v7, s83
    s_mov_b32 s53, 1
    s_mov_b64 exec, 1
    buffer_store_dwordx2 v[6:7], v4, s[20:23], s49 offen sc1
    s_mov_b64 exec, -1
    s_branch Lab91
Lap92:
    s_waitcnt vmcnt(0)
    v_mov_b32 v6, s82
    v_mov_b32 v7, s83
    s_mov_b32 s53, 1
    s_mov_b64 exec, 1
    buffer_store_dwordx2 v[6:7], v4, s[20:23], s49 offen sc1
    s_mov_b64 exec, -1
    s_branch Lab93
Lap94:
    s_waitcnt vmcnt(0)
    v_mov_b32 v6, s82
    v_mov_b32 v7, s83
    s_mov_b32 s53, 1
    s_mov_b64 exec, 1
    buffer_store_dwordx2 v[6:7], v4, s[20:23], s49 offen sc1
    s_mov_b64 exec, -1
    s_branch Lab95
Lap96:
    s_waitcnt vmcnt(0)
    v_mov_b32 v6, s82
    v_mov_b32 v7, s83
    s_mov_b32 s53, 1
    s_mov_b64 exec, 1
    buffer_store_dwordx2 v[6:7], v4, s[20:23], s49 offen sc1
    s_mov_b64 exec, -1
    s_branch Lab97
Lap98:
    s_waitcnt vmcnt(0)
    v_mov_b32 v6, s82
    v_mov_b32 v7, s83
    s_mov_b32 s53, 1
    s_mov_b64 exec, 1
    buffer_store_dwordx2 v[6:7], v4, s[20:23], s49 offen sc1
    s_mov_b64 exec, -1
    s_branch Lab99
Lap100:
    s_waitcnt vmcnt(0)
    v_mov_b32 v6, s82
    v_mov_b32 v7, s83
    s_mov_b32 s53, 1
    s_mov_b64 exec, 1
    buffer_store_dwordx2 v[6:7], v4, s[20:23], s49 offen sc1
    s_mov_b64 exec, -1
    s_branch Lab101
Lap102:
    s_waitcnt vmcnt(0)
    v_mov_b32 v6, s82
    v_mov_b32 v7, s83
    s_mov_b32 s53, 1
    s_mov_b64 exec, 1
    buffer_store_dwordx2 v[6:7], v4, s[20:23], s49 offen sc1
    s_mov_b64 exec, -1
    s_branch Lab103
Lap104:
    s_waitcnt vmcnt(0)
    v_mov_b32 v6, s82
    v_mov_b32 v7, s83
    s_mov_b32 s53, 1
    s_mov_b64 exec, 1
    buffer_store_dwordx2 v[6:7], v4, s[20:23], s49 offen sc1
    s_mov_b64 exec, -1
    s_branch Lab105
Lap106:
    s_waitcnt vmcnt(0)
    v_mov_b32 v6, s82
    v_mov_b32 v7, s83
    s_mov_b32 s53, 1
    s_mov_b64 exec, 1
    buffer_store_dwordx2 v[6:7], v4, s[20:23], s49 offen sc1
    s_mov_b64 exec, -1
    s_branch Lab107
Lap108:
    s_waitcnt vmcnt(0)
    v_mov_b32 v6, s82
    v_mov_b32 v7, s83
    s_mov_b32 s53, 1
    s_mov_b64 exec, 1
    buffer_store_dwordx2 v[6:7], v4, s[20:23], s49 offen sc1
    s_mov_b64 exec, -1
    s_branch Lab109
Lap110:
    s_waitcnt vmcnt(0)
    v_mov_b32 v6, s82
    v_mov_b32 v7, s83
    s_mov_b32 s53, 1
    s_mov_b64 exec, 1
    buffer_store_dwordx2 v[6:7], v4, s[20:23], s49 offen sc1
    s_mov_b64 exec, -1
    s_branch Lab111
Lap112:
    s_waitcnt vmcnt(0)
    v_mov_b32 v6, s82
    v_mov_b32 v7, s83
    s_mov_b32 s53, 1
    s_mov_b64 exec, 1
    buffer_store_dwordx2 v[6:7], v4, s[20:23], s49 offen sc1
    s_mov_b64 exec, -1
    s_branch Lab113
Lap114:
    s_waitcnt vmcnt(0)
    v_mov_b32 v6, s82
    v_mov_b32 v7, s83
    s_mov_b32 s53, 1
    s_mov_b64 exec, 1
    buffer_store_dwordx2 v[6:7], v4, s[20:23], s49 offen sc1
    s_mov_b64 exec, -1
    s_branch Lab115
Lap116:
    s_waitcnt vmcnt(0)
    v_mov_b32 v6, s82
    v_mov_b32 v7, s83
    s_mov_b32 s53, 1
    s_mov_b64 exec, 1
    buffer_store_dwordx2 v[6:7], v4, s[20:23], s49 offen sc1
    s_mov_b64 exec, -1
    s_branch Lab117
Lap118:
    s_waitcnt vmcnt(0)
    v_mov_b32 v6, s82
    v_mov_b32 v7, s83
    s_mov_b32 s53, 1
    s_mov_b64 exec, 1
    buffer_store_dwordx2 v[6:7], v4, s[20:23], s49 offen sc1
    s_mov_b64 exec, -1
    s_branch Lab119
Lap120:
    s_waitcnt vmcnt(0)
    v_mov_b32 v6, s82
    v_mov_b32 v7, s83
    s_mov_b32 s53, 1
    s_mov_b64 exec, 1
    buffer_store_dwordx2 v[6:7], v4, s[20:23], s49 offen sc1
    s_mov_b64 exec, -1
    s_branch Lab121
gated_mix__sliding_local_dilated__dense_activation_squared_relu__prompt_kernel_end:
    s_endpgm
.section .rodata,"a"
.p2align 6
.amdhsa_kernel gated_mix__sliding_local_dilated__dense_activation_squared_relu__prompt_kernel
  .amdhsa_next_free_vgpr 256
  .amdhsa_next_free_sgpr 102
  .amdhsa_accum_offset 256
  .amdhsa_group_segment_fixed_size 0
  .amdhsa_kernarg_size 96
  .amdhsa_user_sgpr_count 2
  .amdhsa_user_sgpr_kernarg_segment_ptr 1
  .amdhsa_system_sgpr_workgroup_id_x 1
.end_amdhsa_kernel
```
